```python
import torch

def _softmax(x, axis=-1):
    return torch.softmax(x, dim=axis)
def _gelu(x):
    return torch.nn.functional.gelu(x, approximate="tanh")
def _silu(x):
    return torch.nn.functional.silu(x)
def _sigmoid(x):
    return torch.sigmoid(x)
def _layernorm(x, axis=-1, eps=1e-5):
    m = x.mean(dim=axis, keepdim=True)
    v = x.var(dim=axis, keepdim=True, unbiased=False)
    return (x - m) / torch.sqrt(v + eps)
def _scatter_add(tgt, idx, src, axis=0):
    return tgt.clone().index_add_(axis, idx, src)
def _segment_sum(src, seg, n):
    out = torch.zeros((n,) + src.shape[1:], dtype=src.dtype)
    return out.index_add_(0, seg, src)
def _pad(x, pw):
    flat = tuple(v for pair in reversed(pw) for v in pair)
    return torch.nn.functional.pad(x, flat)

kernel_name = 'standalone__sliding_block_cached__sampling'

def setup_inputs():

    _w = (lambda a: (lambda t: t.to(torch.bfloat16) if t.is_floating_point() else t)(torch.as_tensor(a)))
    B, Sq, D = 16, 4, 512
    Hq, Hkv, Sk, Dh = 32, 8, 4096, 128
    assert Hq % Hkv == 0, (Hq, Hkv)
    return {
        "x": _w((lambda *s: torch.randn(*s, dtype=torch.bfloat16) * 0.8)(B, Sq, D)),
        "k_cache": _w((lambda *s: torch.randn(*s, dtype=torch.bfloat16) * 0.8)(B, Hkv, Sk, Dh)),
        "v_cache": _w((lambda *s: torch.randn(*s, dtype=torch.bfloat16) * 0.05)(B, Hkv, Sk, Dh)),
        "wq": _w((lambda *s: torch.randn(*s, dtype=torch.bfloat16) * 0.8)(D, Hq * Dh) * (D ** -0.5)),
        "wo": _w((lambda *s: torch.randn(*s, dtype=torch.bfloat16) * 0.05)(Hq * Dh, D) * ((Hq * Dh) ** -0.5)),
    }

def reference(x, k_cache, v_cache, wq, wo):
    B, Sq, D = x.shape
    Hq, Dh = 32, 128
    Hkv, Sk = k_cache.shape[1], k_cache.shape[2]
    W = min(4096, max(256, Sk // 4))
    rep = Hq // Hkv
    q = (lambda x, *d: x.permute(*d))((x @ wq).reshape(B, Sq, Hq, Dh), 0, 2, 1, 3)
    k = (lambda x, n, axis: torch.repeat_interleave(x, n, dim=axis))(k_cache[:, :, Sk - W:, :], rep, axis=1)
    v = (lambda x, n, axis: torch.repeat_interleave(x, n, dim=axis))(v_cache[:, :, Sk - W:, :], rep, axis=1)
    scores = torch.einsum("bhqd,bhkd->bhqk", q, k) * (Dh ** -0.5)
    p = _softmax(scores, axis=-1)
    o = torch.einsum("bhqk,bhkd->bhqd", p, v)
    return (lambda x, *d: x.permute(*d))(o, 0, 2, 1, 3).reshape(B, Sq, Hq * Dh) @ wo
```

```asm
; @launch grid=(256,1,1) block=(512,1,1) lds=163840
.amdgcn_target "amdgcn-amd-amdhsa--gfx950"
.text
.globl standalone__sliding_block_cached__sampling_kernel
.p2align 8
.type standalone__sliding_block_cached__sampling_kernel,@function
standalone__sliding_block_cached__sampling_kernel:
    s_cmp_ge_u32 s2, 256
    s_cbranch_scc1 L_end
    s_load_dwordx16 s[36:51], s[0:1], 0
    v_lshrrev_b32 v1, 6, v0
    v_and_b32 v0, 63, v0
    v_mov_b32 v3, 156224
    v_readfirstlane_b32 s3, v1
    v_mov_b32 v4, 0
    v_mov_b32 v5, 0
    v_mov_b32 v6, 0
    v_mov_b32 v7, 0
    s_and_b32 s4, s2, 7
    s_lshr_b32 s5, s2, 3
    s_lshr_b32 s6, s5, 1
    s_and_b32 s7, s5, 1
    s_lshr_b32 s52, s5, 3
    s_and_b32 s53, s5, 7
    s_and_b32 s54, s53, 1
    s_lshr_b32 s55, s53, 1
    s_lshl_b32 s56, s4, 2
    s_add_u32 s56, s56, s52
    s_and_b32 s57, s3, 3
    s_getreg_b32 s71, hwreg(HW_REG_XCC_ID, 0, 4)
    s_cmp_lg_u32 s3, 0
    s_cbranch_scc1 L_noinit
    ds_write_b128 v3, v[4:7]
L_noinit:
    v_and_b32 v1, 15, v0
    v_lshrrev_b32 v2, 4, v0
    v_lshlrev_b32 v208, 4, v0
    s_lshl_b32 s60, s6, 3
    s_add_u32 s60, s60, s4
    s_lshl_b32 s60, s60, 20
    s_lshl_b32 s61, s7, 17
    s_add_u32 s60, s60, s61
    s_add_u32 s60, s60, 786432
    s_lshl_b32 s61, s52, 8
    s_add_u32 s61, s61, 262144
    s_mov_b32 s10, 131072
    s_mov_b32 s11, 0x20000
    s_mov_b32 s14, 131072
    s_mov_b32 s15, 0x20000
    s_mov_b32 s18, 4194304
    s_mov_b32 s19, 0x20000
    s_mov_b32 s22, 4194304
    s_mov_b32 s23, 0x20000
    s_mov_b32 s26, 65536
    s_mov_b32 s27, 0x20000
    s_mov_b32 s30, 10485760
    s_mov_b32 s31, 0x20000
    s_mov_b32 s34, 65536
    s_mov_b32 s35, 0x20000
    s_waitcnt lgkmcnt(0)
    s_add_u32 s8, s38, s60
    s_addc_u32 s9, s39, 0
    s_mov_b32 s16, s42
    s_mov_b32 s17, s43
    s_add_u32 s64, s50, s61
    s_addc_u32 s65, s51, 0
    s_load_dword s58, s[64:65], 0
    s_add_u32 s12, s40, s60
    s_addc_u32 s13, s41, 0
    s_mov_b32 s20, s44
    s_mov_b32 s21, s45
    s_mov_b32 s24, s36
    s_mov_b32 s25, s37
    s_mov_b32 s28, s50
    s_mov_b32 s29, s51
    s_mov_b32 s32, s46
    s_mov_b32 s33, s47
    s_barrier
    s_cmp_ge_u32 s3, 4
    s_cbranch_scc1 L_cwave
    s_setprio 2
    s_lshl_b32 s60, s5, 4
    s_lshl_b32 s61, s57, 2
    s_add_u32 s60, s60, s61
    s_lshl_b32 s60, s60, 13
    s_lshl_b32 s61, s4, 10
    s_add_u32 s60, s60, s61
    s_add_u32 s60, s60, 384
    s_add_u32 s98, s42, s60
    s_addc_u32 s99, s43, 0
    s_load_dword s100, s[98:99], 0
    s_load_dword s101, s[98:99], 64
    s_load_dword s100, s[98:99], 8192
    s_load_dword s101, s[98:99], 8256
    s_load_dword s100, s[98:99], 16384
    s_load_dword s101, s[98:99], 16448
    s_load_dword s100, s[98:99], 24576
    s_load_dword s101, s[98:99], 24640
    v_lshlrev_b32 v3, 10, v1
    v_add_u32 v4, 0, v2
    v_xor_b32 v4, v4, v1
    v_lshl_add_u32 v116, v4, 4, v3
    v_add_u32 v4, 4, v2
    v_xor_b32 v4, v4, v1
    v_lshl_add_u32 v117, v4, 4, v3
    v_add_u32 v4, 8, v2
    v_xor_b32 v4, v4, v1
    v_lshl_add_u32 v118, v4, 4, v3
    v_add_u32 v4, 12, v2
    v_xor_b32 v4, v4, v1
    v_lshl_add_u32 v119, v4, 4, v3
    s_lshl_b32 s60, s56, 3
    s_add_u32 s60, s60, s53
    s_lshl_b32 s60, s60, 13
    s_add_u32 s90, s60, 2101248
    s_lshl_b32 s61, s57, 10
    s_add_u32 s60, s60, s61
    s_add_u32 s48, s60, 2097152
    v_lshrrev_b32 v4, 2, v1
    v_lshlrev_b32 v4, 14, v4
    v_and_b32 v5, 3, v0
    v_lshl_add_u32 v216, v5, 4, v4
    v_lshl_add_u32 v209, v2, 8, v216
    s_lshr_b32 s61, s3, 2
    s_lshl_b32 s49, s54, 1
    s_add_u32 s61, s61, s49
    s_lshl_b32 s61, s61, 6
    s_lshl_b32 s60, s56, 16
    s_add_u32 s60, s60, s61
    s_add_u32 s91, s60, 2101248
    s_lshl_b32 s61, s57, 10
    s_add_u32 s60, s60, s61
    s_add_u32 s49, s60, 2097152
    s_add_u32 s50, s49, 8192
    s_add_u32 s92, s91, 8192
    v_bfe_u32 v4, v0, 2, 2
    v_lshl_add_u32 v4, v2, 2, v4
    v_lshlrev_b32 v5, 8, v4
    v_and_b32 v4, 7, v4
    v_xor_b32 v4, s3, v4
    v_lshl_add_u32 v5, v4, 5, v5
    v_and_b32 v4, 3, v0
    v_lshl_add_u32 v210, v4, 3, v5
    s_lshl_b32 s60, s52, 2
    s_add_u32 s60, s60, s55
    s_lshl_b32 s60, s60, 17
    s_add_u32 s60, s60, 4194304
    s_lshl_b32 s95, s4, 1
    s_add_u32 s95, s95, s54
    s_lshl_b32 s61, s3, 10
    s_add_u32 s51, s60, s61
    s_lshl_b32 s61, s95, 13
    s_add_u32 s51, s51, s61
    v_lshlrev_b32 v4, 6, v1
    v_lshl_add_u32 v211, v2, 4, v4
    s_lshl_b32 s61, s3, 12
    s_add_u32 s60, s60, s61
    s_lshl_b32 s61, s95, 6
    s_add_u32 s93, s60, s61
    v_lshlrev_b32 v4, 13, v2
    v_bfe_u32 v5, v0, 2, 2
    v_lshl_add_u32 v4, v5, 10, v4
    v_and_b32 v5, 3, v0
    v_lshl_add_u32 v212, v5, 4, v4
    s_lshl_b32 s60, s52, 4
    s_add_u32 s60, s60, s95
    s_lshl_b32 s60, s60, 10
    s_lshl_b32 s61, s55, 8
    s_add_u32 s60, s60, s61
    s_lshl_b32 s61, s3, 7
    s_add_u32 s94, s60, s61
    s_lshl_b32 s60, s3, 10
    s_add_u32 s60, s60, 147456
    v_add_u32 v213, s60, v208
    v_add_u32 v214, 147456, v208
    v_bfe_u32 v5, v0, 2, 2
    v_lshrrev_b32 v6, 1, v5
    v_and_b32 v7, 1, v2
    v_lshl_add_u32 v6, v7, 1, v6
    v_xor_b32 v6, s57, v6
    v_lshl_add_u32 v5, v2, 3, v5
    v_lshlrev_b32 v5, 7, v5
    v_and_b32 v7, 3, v0
    v_lshl_add_u32 v5, v7, 3, v5
    v_lshl_add_u32 v5, v6, 5, v5
    v_add_u32 v120, 65536, v5
    s_lshl_b32 s60, s56, 3
    s_add_u32 s60, s60, s53
    s_lshl_b32 s60, s60, 12
    s_lshl_b32 s61, s57, 10
    s_add_u32 s60, s60, s61
    s_add_u32 s68, s60, 1048576
    s_and_b32 s60, s57, 1
    s_lshl_b32 s60, s60, 2
    v_add_u32 v110, s60, v2
    v_lshlrev_b32 v110, 1, v110
    v_xor_b32 v110, v110, v1
    v_lshlrev_b32 v110, 4, v110
    v_lshl_add_u32 v111, v2, 10, v110
    v_lshl_add_u32 v110, v2, 8, v110
    s_lshl_b32 s60, s4, 9
    s_lshl_b32 s61, s54, 8
    s_add_u32 s60, s60, s61
    s_lshl_b32 s61, s57, 2
    s_add_u32 s60, s60, s61
    s_lshl_b32 s60, s60, 10
    s_lshl_b32 s61, s55, 8
    s_add_u32 s60, s60, s61
    v_add_u32 v111, s60, v111
    v_mov_b32 v100, 156232
    s_mov_b32 s62, 0
L_wqwait:
    ds_read_b32 v101, v100
    s_add_u32 s62, s62, 1
    s_waitcnt lgkmcnt(0)
    v_readfirstlane_b32 s60, v101
    s_cmp_gt_u32 s62, 0x8000000
    s_cbranch_scc1 L_wqwait_done
    s_cmp_ge_u32 s60, 4
    s_cbranch_scc1 L_wqwait_done
    s_sleep 1
    s_branch L_wqwait
L_wqwait_done:
    s_mul_i32 s58, s58, 0x9E3779B1
    s_add_u32 s58, s58, 0x85EBCA6B
    s_or_b32 s58, s58, 1
    ds_read_b128 v[124:127], v116 offset:0
    ds_read_b64_tr_b16 v[24:25], v120 offset:0
    ds_read_b64_tr_b16 v[26:27], v120 offset:512
    ds_read_b128 v[128:131], v117 offset:0
    ds_read_b64_tr_b16 v[28:29], v120 offset:4096
    ds_read_b64_tr_b16 v[30:31], v120 offset:4608
    ds_read_b128 v[132:135], v118 offset:0
    ds_read_b64_tr_b16 v[32:33], v120 offset:8192
    ds_read_b64_tr_b16 v[34:35], v120 offset:8704
    ds_read_b128 v[136:139], v119 offset:0
    ds_read_b64_tr_b16 v[36:37], v120 offset:12288
    ds_read_b64_tr_b16 v[38:39], v120 offset:12800
    ds_read_b128 v[140:143], v116 offset:256
    ds_read_b64_tr_b16 v[40:41], v120 offset:16384
    ds_read_b64_tr_b16 v[42:43], v120 offset:16896
    ds_read_b128 v[144:147], v117 offset:256
    ds_read_b64_tr_b16 v[44:45], v120 offset:20480
    ds_read_b64_tr_b16 v[46:47], v120 offset:20992
    ds_read_b128 v[148:151], v118 offset:256
    ds_read_b64_tr_b16 v[48:49], v120 offset:24576
    ds_read_b64_tr_b16 v[50:51], v120 offset:25088
    ds_read_b128 v[152:155], v119 offset:256
    ds_read_b64_tr_b16 v[52:53], v120 offset:28672
    ds_read_b64_tr_b16 v[54:55], v120 offset:29184
    ds_read_b128 v[156:159], v116 offset:512
    ds_read_b64_tr_b16 v[56:57], v120 offset:32768
    ds_read_b64_tr_b16 v[58:59], v120 offset:33280
    ds_read_b128 v[160:163], v117 offset:512
    ds_read_b64_tr_b16 v[60:61], v120 offset:36864
    ds_read_b64_tr_b16 v[62:63], v120 offset:37376
    ds_read_b128 v[164:167], v118 offset:512
    ds_read_b64_tr_b16 v[64:65], v120 offset:40960
    ds_read_b64_tr_b16 v[66:67], v120 offset:41472
    ds_read_b128 v[168:171], v119 offset:512
    ds_read_b64_tr_b16 v[68:69], v120 offset:45056
    ds_read_b64_tr_b16 v[70:71], v120 offset:45568
    ds_read_b128 v[172:175], v116 offset:768
    ds_read_b64_tr_b16 v[72:73], v120 offset:49152
    ds_read_b64_tr_b16 v[74:75], v120 offset:49664
    ds_read_b128 v[176:179], v117 offset:768
    ds_read_b64_tr_b16 v[76:77], v120 offset:53248
    ds_read_b64_tr_b16 v[78:79], v120 offset:53760
    ds_read_b128 v[180:183], v118 offset:768
    ds_read_b64_tr_b16 v[80:81], v120 offset:57344
    ds_read_b64_tr_b16 v[82:83], v120 offset:57856
    ds_read_b128 v[184:187], v119 offset:768
    ds_read_b64_tr_b16 v[84:85], v120 offset:61440
    ds_read_b64_tr_b16 v[86:87], v120 offset:61952
    s_waitcnt lgkmcnt(15)
    v_mfma_f32_16x16x32_bf16 v[88:91], v[24:27], v[124:127], 0
    s_waitcnt lgkmcnt(15)
    v_mfma_f32_16x16x32_bf16 v[92:95], v[28:31], v[128:131], 0
    s_waitcnt lgkmcnt(15)
    v_mfma_f32_16x16x32_bf16 v[88:91], v[32:35], v[132:135], v[88:91]
    s_waitcnt lgkmcnt(15)
    v_mfma_f32_16x16x32_bf16 v[92:95], v[36:39], v[136:139], v[92:95]
    s_waitcnt lgkmcnt(15)
    v_mfma_f32_16x16x32_bf16 v[88:91], v[40:43], v[140:143], v[88:91]
    s_waitcnt lgkmcnt(15)
    v_mfma_f32_16x16x32_bf16 v[92:95], v[44:47], v[144:147], v[92:95]
    s_waitcnt lgkmcnt(15)
    v_mfma_f32_16x16x32_bf16 v[88:91], v[48:51], v[148:151], v[88:91]
    s_waitcnt lgkmcnt(15)
    v_mfma_f32_16x16x32_bf16 v[92:95], v[52:55], v[152:155], v[92:95]
    s_waitcnt lgkmcnt(15)
    v_mfma_f32_16x16x32_bf16 v[88:91], v[56:59], v[156:159], v[88:91]
    s_waitcnt lgkmcnt(15)
    v_mfma_f32_16x16x32_bf16 v[92:95], v[60:63], v[160:163], v[92:95]
    s_waitcnt lgkmcnt(15)
    v_mfma_f32_16x16x32_bf16 v[88:91], v[64:67], v[164:167], v[88:91]
    s_waitcnt lgkmcnt(12)
    v_mfma_f32_16x16x32_bf16 v[92:95], v[68:71], v[168:171], v[92:95]
    s_waitcnt lgkmcnt(9)
    v_mfma_f32_16x16x32_bf16 v[88:91], v[72:75], v[172:175], v[88:91]
    s_waitcnt lgkmcnt(6)
    v_mfma_f32_16x16x32_bf16 v[92:95], v[76:79], v[176:179], v[92:95]
    s_waitcnt lgkmcnt(3)
    v_mfma_f32_16x16x32_bf16 v[88:91], v[80:83], v[180:183], v[88:91]
    s_waitcnt lgkmcnt(0)
    v_mfma_f32_16x16x32_bf16 v[92:95], v[84:87], v[184:187], v[92:95]
    v_mov_b32 v10, s58
    v_mov_b32 v11, s71
    v_mov_b32 v100, 156224
    v_mov_b32 v101, 1
    s_mov_b64 exec, 1
    ds_add_u32 v100, v101
    s_mov_b64 exec, -1
    s_nop 1
    v_add_f32 v24, v88, v92
    v_add_f32 v25, v89, v93
    v_add_f32 v26, v90, v94
    v_add_f32 v27, v91, v95
    v_mov_b32 v28, v24
    v_mov_b32 v29, v25
    v_mov_b32 v30, v26
    v_mov_b32 v31, v27
    s_mov_b32 s63, 0x3f7fc000
    s_mov_b32 s69, 0x4b400000
    v_permlane16_swap_b32 v24, v28
    v_permlane16_swap_b32 v25, v29
    v_permlane16_swap_b32 v26, v30
    v_permlane16_swap_b32 v27, v31
    s_mov_b32 s60, 0x7ff
    s_mov_b32 s61, 0x3fffff
    v_max3_f32 v12, abs(v24), abs(v25), abs(v26)
    v_max3_f32 v13, abs(v27), abs(v28), abs(v29)
    v_max3_f32 v12, v12, abs(v30), abs(v31)
    v_max_f32 v12, v12, v13
    v_frexp_exp_i32_f32 v12, v12
    v_max_i32 v12, 0xffffff9c, v12
    v_sub_u32 v13, 10, v12
    v_ldexp_f32 v13, s63, v13
    v_add_u32 v12, 110, v12
    v_mul_f32 v14, 0.5, v13
    v_fma_f32 v24, v24, v13, s69
    v_fma_f32 v25, v25, v13, s69
    v_fma_f32 v26, v26, v14, s69
    v_fma_f32 v27, v27, v13, s69
    v_fma_f32 v28, v28, v13, s69
    v_fma_f32 v29, v29, v14, s69
    v_fma_f32 v30, v30, v14, s69
    v_fma_f32 v31, v31, v14, s69
    v_lshlrev_b32 v25, 11, v25
    v_lshlrev_b32 v26, 22, v26
    v_lshlrev_b32 v28, 11, v28
    v_lshlrev_b32 v29, 22, v29
    v_lshlrev_b32 v31, 10, v31
    v_lshl_or_b32 v12, v11, 8, v12
    v_lshlrev_b32 v12, 20, v12
    v_bfi_b32 v24, s60, v24, v25
    v_bfi_b32 v27, s60, v27, v28
    s_mov_b32 s60, 0x3ff
    v_bfi_b32 v8, s61, v24, v26
    v_bfi_b32 v9, s61, v27, v29
    s_mov_b32 s61, 0xfffff
    v_bfi_b32 v30, s60, v30, v31
    v_mov_b32 v11, v10
    v_bfi_b32 v10, s61, v30, v12
    v_lshrrev_b32 v13, 1, v2
    v_lshlrev_b32 v13, 8, v13
    v_lshl_add_u32 v13, v1, 4, v13
    s_mov_b32 exec_lo, 0x0000ffff
    s_mov_b32 exec_hi, 0x0000ffff
    buffer_store_dwordx4 v[8:11], v13, s[28:31], s68 offen
    s_mov_b64 exec, -1
    s_setprio 0
    v_mov_b32 v100, 156224
    s_mov_b32 s62, 0
L_stgfree:
    ds_read_b32 v101, v100
    s_add_u32 s62, s62, 1
    s_waitcnt lgkmcnt(0)
    v_readfirstlane_b32 s60, v101
    s_cmp_gt_u32 s62, 0x8000000
    s_cbranch_scc1 L_stgfree_done
    s_cmp_ge_u32 s60, 4
    s_cbranch_scc1 L_stgfree_done
    s_branch L_stgfree
L_stgfree_done:
    s_barrier
    s_lshl_b32 s63, s57, 10
    s_add_u32 s60, s63, 0
    s_mov_b32 m0, s60
    s_nop 0
    buffer_load_dwordx4 v110, s[12:15], s60 offen nt lds
    s_add_u32 s60, s63, 4096
    s_mov_b32 m0, s60
    s_nop 0
    buffer_load_dwordx4 v110, s[12:15], s60 offen nt lds
    s_add_u32 s60, s63, 8192
    s_mov_b32 m0, s60
    s_nop 0
    buffer_load_dwordx4 v110, s[12:15], s60 offen nt lds
    s_add_u32 s60, s63, 12288
    s_mov_b32 m0, s60
    s_nop 0
    buffer_load_dwordx4 v110, s[12:15], s60 offen nt lds
    s_add_u32 s60, s63, 16384
    s_mov_b32 m0, s60
    s_nop 0
    buffer_load_dwordx4 v110, s[12:15], s60 offen nt lds
    s_add_u32 s60, s63, 20480
    s_mov_b32 m0, s60
    s_nop 0
    buffer_load_dwordx4 v110, s[12:15], s60 offen nt lds
    s_add_u32 s60, s63, 24576
    s_mov_b32 m0, s60
    s_nop 0
    buffer_load_dwordx4 v110, s[12:15], s60 offen nt lds
    s_add_u32 s60, s63, 28672
    s_mov_b32 m0, s60
    s_nop 0
    buffer_load_dwordx4 v110, s[12:15], s60 offen nt lds
    s_add_u32 s60, s63, 32768
    s_mov_b32 m0, s60
    s_nop 0
    buffer_load_dwordx4 v110, s[12:15], s60 offen nt lds
    s_add_u32 s60, s63, 36864
    s_mov_b32 m0, s60
    s_nop 0
    buffer_load_dwordx4 v110, s[12:15], s60 offen nt lds
    s_add_u32 s60, s63, 40960
    s_mov_b32 m0, s60
    s_nop 0
    buffer_load_dwordx4 v110, s[12:15], s60 offen nt lds
    s_add_u32 s60, s63, 45056
    s_mov_b32 m0, s60
    s_nop 0
    buffer_load_dwordx4 v110, s[12:15], s60 offen nt lds
    s_add_u32 s60, s63, 49152
    s_mov_b32 m0, s60
    s_nop 0
    buffer_load_dwordx4 v110, s[12:15], s60 offen nt lds
    s_add_u32 s60, s63, 53248
    s_mov_b32 m0, s60
    s_nop 0
    buffer_load_dwordx4 v110, s[12:15], s60 offen nt lds
    s_add_u32 s60, s63, 57344
    s_mov_b32 m0, s60
    s_nop 0
    buffer_load_dwordx4 v110, s[12:15], s60 offen nt lds
    s_add_u32 s60, s63, 61440
    s_mov_b32 m0, s60
    s_nop 0
    buffer_load_dwordx4 v110, s[12:15], s60 offen nt lds
    s_add_u32 s60, s63, 65536
    s_mov_b32 m0, s60
    s_nop 0
    buffer_load_dwordx4 v110, s[12:15], s60 offen nt lds
    s_add_u32 s60, s63, 69632
    s_mov_b32 m0, s60
    s_nop 0
    buffer_load_dwordx4 v110, s[12:15], s60 offen nt lds
    s_add_u32 s60, s63, 73728
    s_mov_b32 m0, s60
    s_nop 0
    buffer_load_dwordx4 v110, s[12:15], s60 offen nt lds
    s_add_u32 s60, s63, 77824
    s_mov_b32 m0, s60
    s_nop 0
    buffer_load_dwordx4 v110, s[12:15], s60 offen nt lds
    s_add_u32 s60, s63, 81920
    s_mov_b32 m0, s60
    s_nop 0
    buffer_load_dwordx4 v110, s[12:15], s60 offen nt lds
    s_add_u32 s60, s63, 86016
    s_mov_b32 m0, s60
    s_nop 0
    buffer_load_dwordx4 v110, s[12:15], s60 offen nt lds
    s_add_u32 s60, s63, 90112
    s_mov_b32 m0, s60
    s_nop 0
    buffer_load_dwordx4 v110, s[12:15], s60 offen nt lds
    s_add_u32 s60, s63, 94208
    s_mov_b32 m0, s60
    s_nop 0
    buffer_load_dwordx4 v110, s[12:15], s60 offen nt lds
    s_add_u32 s60, s63, 98304
    s_mov_b32 m0, s60
    s_nop 0
    buffer_load_dwordx4 v110, s[12:15], s60 offen nt lds
    s_add_u32 s60, s63, 102400
    s_mov_b32 m0, s60
    s_nop 0
    buffer_load_dwordx4 v110, s[12:15], s60 offen nt lds
    s_add_u32 s60, s63, 106496
    s_mov_b32 m0, s60
    s_nop 0
    buffer_load_dwordx4 v110, s[12:15], s60 offen nt lds
    s_add_u32 s60, s63, 110592
    s_mov_b32 m0, s60
    s_nop 0
    buffer_load_dwordx4 v110, s[12:15], s60 offen nt lds
    s_add_u32 s60, s63, 114688
    s_mov_b32 m0, s60
    s_nop 0
    buffer_load_dwordx4 v110, s[12:15], s60 offen nt lds
    s_add_u32 s60, s63, 118784
    s_mov_b32 m0, s60
    s_nop 0
    buffer_load_dwordx4 v110, s[12:15], s60 offen nt lds
    s_add_u32 s60, s63, 122880
    s_mov_b32 m0, s60
    s_nop 0
    buffer_load_dwordx4 v110, s[12:15], s60 offen nt lds
    s_add_u32 s60, s63, 126976
    s_mov_b32 m0, s60
    s_nop 0
    buffer_load_dwordx4 v110, s[12:15], s60 offen nt lds
    s_waitcnt vmcnt(16)
    s_barrier
    v_mov_b32 v100, 156236
    ds_read_b32 v101, v100
    s_waitcnt lgkmcnt(0)
    v_readfirstlane_b32 s70, v101
    s_lshr_b32 s70, s70, 8
    s_barrier
    s_add_u32 m0, s63, 0
    s_mov_b32 s60, 0
    buffer_load_dwordx4 v111, s[20:23], s60 offen nt lds
    s_add_u32 m0, s63, 4096
    s_mov_b32 s60, 16384
    buffer_load_dwordx4 v111, s[20:23], s60 offen nt lds
    s_add_u32 m0, s63, 8192
    s_mov_b32 s60, 32768
    buffer_load_dwordx4 v111, s[20:23], s60 offen nt lds
    s_add_u32 m0, s63, 12288
    s_mov_b32 s60, 49152
    buffer_load_dwordx4 v111, s[20:23], s60 offen nt lds
    s_add_u32 m0, s63, 16384
    s_mov_b32 s60, 65536
    buffer_load_dwordx4 v111, s[20:23], s60 offen nt lds
    s_add_u32 m0, s63, 20480
    s_mov_b32 s60, 81920
    buffer_load_dwordx4 v111, s[20:23], s60 offen nt lds
    s_add_u32 m0, s63, 24576
    s_mov_b32 s60, 98304
    buffer_load_dwordx4 v111, s[20:23], s60 offen nt lds
    s_add_u32 m0, s63, 28672
    s_mov_b32 s60, 114688
    buffer_load_dwordx4 v111, s[20:23], s60 offen nt lds
    s_add_u32 m0, s63, 32768
    s_mov_b32 s60, 131072
    buffer_load_dwordx4 v111, s[20:23], s60 offen nt lds
    s_add_u32 m0, s63, 36864
    s_mov_b32 s60, 147456
    buffer_load_dwordx4 v111, s[20:23], s60 offen nt lds
    s_add_u32 m0, s63, 40960
    s_mov_b32 s60, 163840
    buffer_load_dwordx4 v111, s[20:23], s60 offen nt lds
    s_add_u32 m0, s63, 45056
    s_mov_b32 s60, 180224
    buffer_load_dwordx4 v111, s[20:23], s60 offen nt lds
    s_waitcnt vmcnt(16)
    s_barrier
    s_add_u32 m0, s63, 49152
    s_mov_b32 s60, 196608
    buffer_load_dwordx4 v111, s[20:23], s60 offen nt lds
    s_add_u32 m0, s63, 53248
    s_mov_b32 s60, 212992
    buffer_load_dwordx4 v111, s[20:23], s60 offen nt lds
    s_add_u32 m0, s63, 57344
    s_mov_b32 s60, 229376
    buffer_load_dwordx4 v111, s[20:23], s60 offen nt lds
    s_add_u32 m0, s63, 61440
    s_mov_b32 s60, 245760
    buffer_load_dwordx4 v111, s[20:23], s60 offen nt lds
    s_waitcnt vmcnt(16)
    s_barrier
    s_waitcnt vmcnt(10)
    s_branch L_join2L
L_cwave:
    s_setprio 1
    v_and_b32 v3, 7, v0
    v_lshlrev_b32 v3, 8, v3
    v_bfe_u32 v4, v0, 3, 1
    v_lshl_add_u32 v3, v4, 6, v3
    v_lshl_add_u32 v3, v2, 4, v3
    s_lshl_b32 s60, s57, 13
    v_add_u32 v3, s60, v3
    s_lshl_b32 s60, s4, 10
    s_lshl_b32 s61, s53, 7
    s_add_u32 s60, s60, s61
    s_lshl_b32 s61, s57, 20
    s_add_u32 s60, s60, s61
    v_lshrrev_b32 v4, 3, v0
    v_lshlrev_b32 v4, 13, v4
    v_bfe_u32 v6, v0, 4, 1
    v_bfe_u32 v7, v0, 1, 2
    v_xor_b32 v6, v6, v7
    v_and_b32 v7, 1, v0
    v_lshl_add_u32 v5, v6, 1, v7
    v_lshlrev_b32 v5, 4, v5
    v_add3_u32 v10, v4, v5, s60
    v_xor_b32 v6, 2, v6
    v_lshl_add_u32 v5, v6, 1, v7
    v_lshlrev_b32 v5, 4, v5
    v_add3_u32 v11, v4, v5, s60
    s_lshl_b32 s69, s57, 14
    s_add_u32 s69, s69, 65536
    s_lshl_b32 s68, s57, 2
    v_xor_b32 v9, s68, v0
    s_cmp_eq_u32 s53, 3
    s_cbranch_scc1 L_seq3
    s_add_u32 m0, s69, 0
    s_mov_b32 s61, 0
    buffer_load_dwordx4 v10, s[16:19], s61 offen nt lds
    s_add_u32 m0, s69, 1024
    s_mov_b32 s61, 65536
    buffer_load_dwordx4 v11, s[16:19], s61 offen nt lds
    buffer_load_dwordx4 v[16:19], v3, s[8:11], 0 offen offset:0 nt
    s_add_u32 m0, s69, 2048
    s_mov_b32 s61, 131072
    buffer_load_dwordx4 v10, s[16:19], s61 offen nt lds
    s_add_u32 m0, s69, 3072
    s_mov_b32 s61, 196608
    buffer_load_dwordx4 v11, s[16:19], s61 offen nt lds
    buffer_load_dwordx4 v[24:27], v3, s[8:11], 0 offen offset:128 nt
    v_xor_b32 v8, 0, v9
    v_lshlrev_b32 v8, 4, v8
    s_add_u32 s60, s68, 0
    s_lshl_b32 s61, s52, 4
    s_add_u32 s61, s61, s60
    s_lshl_b32 s61, s61, 10
    s_lshl_b32 m0, s60, 10
    s_nop 0
    buffer_load_dwordx4 v8, s[24:27], s61 offen  lds
    v_xor_b32 v8, 1, v9
    v_lshlrev_b32 v8, 4, v8
    s_add_u32 s60, s68, 1
    s_lshl_b32 s61, s52, 4
    s_add_u32 s61, s61, s60
    s_lshl_b32 s61, s61, 10
    s_lshl_b32 m0, s60, 10
    s_nop 0
    buffer_load_dwordx4 v8, s[24:27], s61 offen  lds
    v_xor_b32 v8, 2, v9
    v_lshlrev_b32 v8, 4, v8
    s_add_u32 s60, s68, 2
    s_lshl_b32 s61, s52, 4
    s_add_u32 s61, s61, s60
    s_lshl_b32 s61, s61, 10
    s_lshl_b32 m0, s60, 10
    s_nop 0
    buffer_load_dwordx4 v8, s[24:27], s61 offen  lds
    v_xor_b32 v8, 3, v9
    v_lshlrev_b32 v8, 4, v8
    s_add_u32 s60, s68, 3
    s_lshl_b32 s61, s52, 4
    s_add_u32 s61, s61, s60
    s_lshl_b32 s61, s61, 10
    s_lshl_b32 m0, s60, 10
    s_nop 0
    buffer_load_dwordx4 v8, s[24:27], s61 offen  lds
    s_add_u32 m0, s69, 4096
    s_mov_b32 s61, 262144
    buffer_load_dwordx4 v10, s[16:19], s61 offen nt lds
    s_add_u32 m0, s69, 5120
    s_mov_b32 s61, 327680
    buffer_load_dwordx4 v11, s[16:19], s61 offen nt lds
    buffer_load_dwordx4 v[32:35], v3, s[8:11], 0 offen offset:2048 nt
    s_add_u32 m0, s69, 6144
    s_mov_b32 s61, 393216
    buffer_load_dwordx4 v10, s[16:19], s61 offen nt lds
    s_add_u32 m0, s69, 7168
    s_mov_b32 s61, 458752
    buffer_load_dwordx4 v11, s[16:19], s61 offen nt lds
    buffer_load_dwordx4 v[40:43], v3, s[8:11], 0 offen offset:2176 nt
    s_add_u32 m0, s69, 8192
    s_mov_b32 s61, 524288
    buffer_load_dwordx4 v10, s[16:19], s61 offen nt lds
    s_add_u32 m0, s69, 9216
    s_mov_b32 s61, 589824
    buffer_load_dwordx4 v11, s[16:19], s61 offen nt lds
    s_mov_b32 s63, 4096
    buffer_load_dwordx4 v[20:23], v3, s[8:11], s63 offen offset:0 nt
    s_add_u32 m0, s69, 10240
    s_mov_b32 s61, 655360
    buffer_load_dwordx4 v10, s[16:19], s61 offen nt lds
    s_add_u32 m0, s69, 11264
    s_mov_b32 s61, 720896
    buffer_load_dwordx4 v11, s[16:19], s61 offen nt lds
    buffer_load_dwordx4 v[28:31], v3, s[8:11], s63 offen offset:128 nt
    s_add_u32 m0, s69, 12288
    s_mov_b32 s61, 786432
    buffer_load_dwordx4 v10, s[16:19], s61 offen nt lds
    s_add_u32 m0, s69, 13312
    s_mov_b32 s61, 851968
    buffer_load_dwordx4 v11, s[16:19], s61 offen nt lds
    buffer_load_dwordx4 v[36:39], v3, s[8:11], s63 offen offset:2048 nt
    s_add_u32 m0, s69, 14336
    s_mov_b32 s61, 917504
    buffer_load_dwordx4 v10, s[16:19], s61 offen nt lds
    s_add_u32 m0, s69, 15360
    s_mov_b32 s61, 983040
    buffer_load_dwordx4 v11, s[16:19], s61 offen nt lds
    buffer_load_dwordx4 v[44:47], v3, s[8:11], s63 offen offset:2176 nt
    s_mov_b32 s63, 32768
    buffer_load_dwordx4 v[48:51], v3, s[8:11], s63 offen offset:0 nt
    buffer_load_dwordx4 v[56:59], v3, s[8:11], s63 offen offset:128 nt
    buffer_load_dwordx4 v[64:67], v3, s[8:11], s63 offen offset:2048 nt
    buffer_load_dwordx4 v[72:75], v3, s[8:11], s63 offen offset:2176 nt
    s_mov_b32 s63, 36864
    buffer_load_dwordx4 v[52:55], v3, s[8:11], s63 offen offset:0 nt
    buffer_load_dwordx4 v[60:63], v3, s[8:11], s63 offen offset:128 nt
    buffer_load_dwordx4 v[68:71], v3, s[8:11], s63 offen offset:2048 nt
    s_waitcnt vmcnt(8)
    v_mov_b32 v8, 156232
    v_mov_b32 v9, 1
    s_mov_b64 exec, 1
    ds_add_u32 v8, v9
    s_mov_b64 exec, -1
    buffer_load_dwordx4 v[76:79], v3, s[8:11], s63 offen offset:2176 nt
    s_mov_b32 s63, 65536
    buffer_load_dwordx4 v[80:83], v3, s[8:11], s63 offen offset:0 nt
    buffer_load_dwordx4 v[88:91], v3, s[8:11], s63 offen offset:128 nt
    buffer_load_dwordx4 v[96:99], v3, s[8:11], s63 offen offset:2048 nt
    buffer_load_dwordx4 v[104:107], v3, s[8:11], s63 offen offset:2176 nt
    s_mov_b32 s63, 69632
    buffer_load_dwordx4 v[84:87], v3, s[8:11], s63 offen offset:0 nt
    buffer_load_dwordx4 v[92:95], v3, s[8:11], s63 offen offset:128 nt
    buffer_load_dwordx4 v[100:103], v3, s[8:11], s63 offen offset:2048 nt
    buffer_load_dwordx4 v[108:111], v3, s[8:11], s63 offen offset:2176 nt
    s_mov_b32 s63, 98304
    buffer_load_dwordx4 v[112:115], v3, s[8:11], s63 offen offset:0 nt
    buffer_load_dwordx4 v[120:123], v3, s[8:11], s63 offen offset:128 nt
    buffer_load_dwordx4 v[128:131], v3, s[8:11], s63 offen offset:2048 nt
    buffer_load_dwordx4 v[136:139], v3, s[8:11], s63 offen offset:2176 nt
    s_mov_b32 s63, 102400
    buffer_load_dwordx4 v[116:119], v3, s[8:11], s63 offen offset:0 nt
    buffer_load_dwordx4 v[124:127], v3, s[8:11], s63 offen offset:128 nt
    buffer_load_dwordx4 v[132:135], v3, s[8:11], s63 offen offset:2048 nt
    buffer_load_dwordx4 v[140:143], v3, s[8:11], s63 offen offset:2176 nt
    s_branch L_seqdone
L_seq3:
    buffer_load_dwordx4 v[16:19], v3, s[8:11], 0 offen offset:0 nt
    buffer_load_dwordx4 v[24:27], v3, s[8:11], 0 offen offset:128 nt
    buffer_load_dwordx4 v[32:35], v3, s[8:11], 0 offen offset:2048 nt
    buffer_load_dwordx4 v[40:43], v3, s[8:11], 0 offen offset:2176 nt
    s_mov_b32 s63, 4096
    buffer_load_dwordx4 v[20:23], v3, s[8:11], s63 offen offset:0 nt
    buffer_load_dwordx4 v[28:31], v3, s[8:11], s63 offen offset:128 nt
    v_xor_b32 v8, 0, v9
    v_lshlrev_b32 v8, 4, v8
    s_add_u32 s60, s68, 0
    s_lshl_b32 s61, s52, 4
    s_add_u32 s61, s61, s60
    s_lshl_b32 s61, s61, 10
    s_lshl_b32 m0, s60, 10
    s_nop 0
    buffer_load_dwordx4 v8, s[24:27], s61 offen  lds
    v_xor_b32 v8, 1, v9
    v_lshlrev_b32 v8, 4, v8
    s_add_u32 s60, s68, 1
    s_lshl_b32 s61, s52, 4
    s_add_u32 s61, s61, s60
    s_lshl_b32 s61, s61, 10
    s_lshl_b32 m0, s60, 10
    s_nop 0
    buffer_load_dwordx4 v8, s[24:27], s61 offen  lds
    v_xor_b32 v8, 2, v9
    v_lshlrev_b32 v8, 4, v8
    s_add_u32 s60, s68, 2
    s_lshl_b32 s61, s52, 4
    s_add_u32 s61, s61, s60
    s_lshl_b32 s61, s61, 10
    s_lshl_b32 m0, s60, 10
    s_nop 0
    buffer_load_dwordx4 v8, s[24:27], s61 offen  lds
    v_xor_b32 v8, 3, v9
    v_lshlrev_b32 v8, 4, v8
    s_add_u32 s60, s68, 3
    s_lshl_b32 s61, s52, 4
    s_add_u32 s61, s61, s60
    s_lshl_b32 s61, s61, 10
    s_lshl_b32 m0, s60, 10
    s_nop 0
    buffer_load_dwordx4 v8, s[24:27], s61 offen  lds
    buffer_load_dwordx4 v[36:39], v3, s[8:11], s63 offen offset:2048 nt
    buffer_load_dwordx4 v[44:47], v3, s[8:11], s63 offen offset:2176 nt
    s_mov_b32 s63, 32768
    buffer_load_dwordx4 v[48:51], v3, s[8:11], s63 offen offset:0 nt
    buffer_load_dwordx4 v[56:59], v3, s[8:11], s63 offen offset:128 nt
    buffer_load_dwordx4 v[64:67], v3, s[8:11], s63 offen offset:2048 nt
    buffer_load_dwordx4 v[72:75], v3, s[8:11], s63 offen offset:2176 nt
    s_add_u32 m0, s69, 0
    s_mov_b32 s61, 0
    buffer_load_dwordx4 v10, s[16:19], s61 offen nt lds
    s_add_u32 m0, s69, 1024
    s_mov_b32 s61, 65536
    buffer_load_dwordx4 v11, s[16:19], s61 offen nt lds
    s_add_u32 m0, s69, 2048
    s_mov_b32 s61, 131072
    buffer_load_dwordx4 v10, s[16:19], s61 offen nt lds
    s_add_u32 m0, s69, 3072
    s_mov_b32 s61, 196608
    buffer_load_dwordx4 v11, s[16:19], s61 offen nt lds
    s_add_u32 m0, s69, 4096
    s_mov_b32 s61, 262144
    buffer_load_dwordx4 v10, s[16:19], s61 offen nt lds
    s_add_u32 m0, s69, 5120
    s_mov_b32 s61, 327680
    buffer_load_dwordx4 v11, s[16:19], s61 offen nt lds
    s_add_u32 m0, s69, 6144
    s_mov_b32 s61, 393216
    buffer_load_dwordx4 v10, s[16:19], s61 offen nt lds
    s_add_u32 m0, s69, 7168
    s_mov_b32 s61, 458752
    buffer_load_dwordx4 v11, s[16:19], s61 offen nt lds
    s_add_u32 m0, s69, 8192
    s_mov_b32 s61, 524288
    buffer_load_dwordx4 v10, s[16:19], s61 offen nt lds
    s_add_u32 m0, s69, 9216
    s_mov_b32 s61, 589824
    buffer_load_dwordx4 v11, s[16:19], s61 offen nt lds
    s_add_u32 m0, s69, 10240
    s_mov_b32 s61, 655360
    buffer_load_dwordx4 v10, s[16:19], s61 offen nt lds
    s_add_u32 m0, s69, 11264
    s_mov_b32 s61, 720896
    buffer_load_dwordx4 v11, s[16:19], s61 offen nt lds
    s_add_u32 m0, s69, 12288
    s_mov_b32 s61, 786432
    buffer_load_dwordx4 v10, s[16:19], s61 offen nt lds
    s_add_u32 m0, s69, 13312
    s_mov_b32 s61, 851968
    buffer_load_dwordx4 v11, s[16:19], s61 offen nt lds
    s_add_u32 m0, s69, 14336
    s_mov_b32 s61, 917504
    buffer_load_dwordx4 v10, s[16:19], s61 offen nt lds
    s_add_u32 m0, s69, 15360
    s_mov_b32 s61, 983040
    buffer_load_dwordx4 v11, s[16:19], s61 offen nt lds
    s_mov_b32 s63, 36864
    buffer_load_dwordx4 v[52:55], v3, s[8:11], s63 offen offset:0 nt
    buffer_load_dwordx4 v[60:63], v3, s[8:11], s63 offen offset:128 nt
    buffer_load_dwordx4 v[68:71], v3, s[8:11], s63 offen offset:2048 nt
    buffer_load_dwordx4 v[76:79], v3, s[8:11], s63 offen offset:2176 nt
    s_mov_b32 s63, 65536
    buffer_load_dwordx4 v[80:83], v3, s[8:11], s63 offen offset:0 nt
    buffer_load_dwordx4 v[88:91], v3, s[8:11], s63 offen offset:128 nt
    s_waitcnt vmcnt(6)
    v_mov_b32 v8, 156232
    v_mov_b32 v9, 1
    s_mov_b64 exec, 1
    ds_add_u32 v8, v9
    s_mov_b64 exec, -1
    buffer_load_dwordx4 v[96:99], v3, s[8:11], s63 offen offset:2048 nt
    buffer_load_dwordx4 v[104:107], v3, s[8:11], s63 offen offset:2176 nt
    s_mov_b32 s63, 69632
    buffer_load_dwordx4 v[84:87], v3, s[8:11], s63 offen offset:0 nt
    buffer_load_dwordx4 v[92:95], v3, s[8:11], s63 offen offset:128 nt
    buffer_load_dwordx4 v[100:103], v3, s[8:11], s63 offen offset:2048 nt
    buffer_load_dwordx4 v[108:111], v3, s[8:11], s63 offen offset:2176 nt
    s_mov_b32 s63, 98304
    buffer_load_dwordx4 v[112:115], v3, s[8:11], s63 offen offset:0 nt
    buffer_load_dwordx4 v[120:123], v3, s[8:11], s63 offen offset:128 nt
    buffer_load_dwordx4 v[128:131], v3, s[8:11], s63 offen offset:2048 nt
    buffer_load_dwordx4 v[136:139], v3, s[8:11], s63 offen offset:2176 nt
    s_mov_b32 s63, 102400
    buffer_load_dwordx4 v[116:119], v3, s[8:11], s63 offen offset:0 nt
    buffer_load_dwordx4 v[124:127], v3, s[8:11], s63 offen offset:128 nt
    buffer_load_dwordx4 v[132:135], v3, s[8:11], s63 offen offset:2048 nt
    buffer_load_dwordx4 v[140:143], v3, s[8:11], s63 offen offset:2176 nt
L_seqdone:
    v_lshrrev_b32 v4, 2, v1
    v_lshlrev_b32 v4, 13, v4
    v_lshrrev_b32 v5, 1, v2
    v_lshl_add_u32 v4, v5, 10, v4
    v_and_b32 v5, 1, v2
    v_lshl_add_u32 v4, v5, 8, v4
    v_and_b32 v5, 3, v0
    v_lshl_add_u32 v215, v5, 4, v4
    s_and_b32 s60, s6, 3
    s_lshl_b32 s60, s60, 6
    s_lshl_b32 s61, s56, 15
    s_add_u32 s60, s60, s61
    s_add_u32 s63, s60, 1048576
    s_lshl_b32 s60, s57, 11
    s_add_u32 s63, s63, s60
    s_waitcnt lgkmcnt(0)
    s_mul_i32 s58, s58, 0x9E3779B1
    s_add_u32 s58, s58, 0x85EBCA6B
    s_or_b32 s58, s58, 1
    s_mov_b32 s62, 0
    s_barrier
    buffer_load_dwordx4 v[160:163], v215, s[28:31], s63 offen nt
    s_lshl_b32 s60, s56, 3
    s_add_u32 s60, s60, s53
    s_lshl_b32 s60, s60, 13
    s_add_u32 s90, s60, 2101248
    s_lshl_b32 s61, s57, 10
    s_add_u32 s60, s60, s61
    s_add_u32 s48, s60, 2097152
    v_lshrrev_b32 v4, 2, v1
    v_lshlrev_b32 v4, 14, v4
    v_and_b32 v5, 3, v0
    v_lshl_add_u32 v216, v5, 4, v4
    v_lshl_add_u32 v209, v2, 8, v216
    s_lshr_b32 s61, s3, 2
    s_lshl_b32 s49, s54, 1
    s_add_u32 s61, s61, s49
    s_lshl_b32 s61, s61, 6
    s_lshl_b32 s60, s56, 16
    s_add_u32 s60, s60, s61
    s_add_u32 s91, s60, 2101248
    s_lshl_b32 s61, s57, 10
    s_add_u32 s60, s60, s61
    s_add_u32 s49, s60, 2097152
    s_add_u32 s50, s49, 8192
    s_add_u32 s92, s91, 8192
    v_bfe_u32 v4, v0, 2, 2
    v_lshl_add_u32 v4, v2, 2, v4
    v_lshlrev_b32 v5, 8, v4
    v_and_b32 v4, 7, v4
    v_xor_b32 v4, s3, v4
    v_lshl_add_u32 v5, v4, 5, v5
    v_and_b32 v4, 3, v0
    v_lshl_add_u32 v210, v4, 3, v5
    s_lshl_b32 s60, s52, 2
    s_add_u32 s60, s60, s55
    s_lshl_b32 s60, s60, 17
    s_add_u32 s60, s60, 4194304
    s_lshl_b32 s95, s4, 1
    s_add_u32 s95, s95, s54
    s_lshl_b32 s61, s3, 10
    s_add_u32 s51, s60, s61
    s_lshl_b32 s61, s95, 13
    s_add_u32 s51, s51, s61
    v_lshlrev_b32 v4, 6, v1
    v_lshl_add_u32 v211, v2, 4, v4
    s_lshl_b32 s61, s3, 12
    s_add_u32 s60, s60, s61
    s_lshl_b32 s61, s95, 6
    s_add_u32 s93, s60, s61
    v_lshlrev_b32 v4, 13, v2
    v_bfe_u32 v5, v0, 2, 2
    v_lshl_add_u32 v4, v5, 10, v4
    v_and_b32 v5, 3, v0
    v_lshl_add_u32 v212, v5, 4, v4
    s_lshl_b32 s60, s52, 4
    s_add_u32 s60, s60, s95
    s_lshl_b32 s60, s60, 10
    s_lshl_b32 s61, s55, 8
    s_add_u32 s60, s60, s61
    s_lshl_b32 s61, s3, 7
    s_add_u32 s94, s60, s61
    s_lshl_b32 s60, s3, 10
    s_add_u32 s60, s60, 147456
    v_add_u32 v213, s60, v208
    v_add_u32 v214, 147456, v208
    s_waitcnt vmcnt(1)
    s_mov_b32 s44, 0x00ff00ff
    s_mov_b32 s45, 0x00ff00ff
    s_mov_b32 s46, 0xff00ff00
    s_mov_b32 s47, 0xff00ff00
    s_mov_b64 vcc, s[44:45]
    v_cndmask_b32_dpp v12, v20, v16, vcc row_ror:8 row_mask:0xf bank_mask:0xf
    v_cndmask_b32_dpp v13, v21, v17, vcc row_ror:8 row_mask:0xf bank_mask:0xf
    v_cndmask_b32_dpp v14, v22, v18, vcc row_ror:8 row_mask:0xf bank_mask:0xf
    v_cndmask_b32_dpp v15, v23, v19, vcc row_ror:8 row_mask:0xf bank_mask:0xf
    s_mov_b64 vcc, s[46:47]
    v_cndmask_b32_dpp v20, v16, v20, vcc row_ror:8 row_mask:0xf bank_mask:0xf
    v_cndmask_b32_dpp v21, v17, v21, vcc row_ror:8 row_mask:0xf bank_mask:0xf
    v_cndmask_b32_dpp v22, v18, v22, vcc row_ror:8 row_mask:0xf bank_mask:0xf
    v_cndmask_b32_dpp v23, v19, v23, vcc row_ror:8 row_mask:0xf bank_mask:0xf
    s_mov_b64 vcc, s[44:45]
    v_cndmask_b32_dpp v16, v28, v24, vcc row_ror:8 row_mask:0xf bank_mask:0xf
    v_cndmask_b32_dpp v17, v29, v25, vcc row_ror:8 row_mask:0xf bank_mask:0xf
    v_cndmask_b32_dpp v18, v30, v26, vcc row_ror:8 row_mask:0xf bank_mask:0xf
    v_cndmask_b32_dpp v19, v31, v27, vcc row_ror:8 row_mask:0xf bank_mask:0xf
    s_mov_b64 vcc, s[46:47]
    v_cndmask_b32_dpp v28, v24, v28, vcc row_ror:8 row_mask:0xf bank_mask:0xf
    v_cndmask_b32_dpp v29, v25, v29, vcc row_ror:8 row_mask:0xf bank_mask:0xf
    v_cndmask_b32_dpp v30, v26, v30, vcc row_ror:8 row_mask:0xf bank_mask:0xf
    v_cndmask_b32_dpp v31, v27, v31, vcc row_ror:8 row_mask:0xf bank_mask:0xf
    s_mov_b64 vcc, s[44:45]
    v_cndmask_b32_dpp v24, v36, v32, vcc row_ror:8 row_mask:0xf bank_mask:0xf
    v_cndmask_b32_dpp v25, v37, v33, vcc row_ror:8 row_mask:0xf bank_mask:0xf
    v_cndmask_b32_dpp v26, v38, v34, vcc row_ror:8 row_mask:0xf bank_mask:0xf
    v_cndmask_b32_dpp v27, v39, v35, vcc row_ror:8 row_mask:0xf bank_mask:0xf
    s_mov_b64 vcc, s[46:47]
    v_cndmask_b32_dpp v36, v32, v36, vcc row_ror:8 row_mask:0xf bank_mask:0xf
    v_cndmask_b32_dpp v37, v33, v37, vcc row_ror:8 row_mask:0xf bank_mask:0xf
    v_cndmask_b32_dpp v38, v34, v38, vcc row_ror:8 row_mask:0xf bank_mask:0xf
    v_cndmask_b32_dpp v39, v35, v39, vcc row_ror:8 row_mask:0xf bank_mask:0xf
    s_mov_b64 vcc, s[44:45]
    v_cndmask_b32_dpp v32, v44, v40, vcc row_ror:8 row_mask:0xf bank_mask:0xf
    v_cndmask_b32_dpp v33, v45, v41, vcc row_ror:8 row_mask:0xf bank_mask:0xf
    v_cndmask_b32_dpp v34, v46, v42, vcc row_ror:8 row_mask:0xf bank_mask:0xf
    v_cndmask_b32_dpp v35, v47, v43, vcc row_ror:8 row_mask:0xf bank_mask:0xf
    s_mov_b64 vcc, s[46:47]
    v_cndmask_b32_dpp v44, v40, v44, vcc row_ror:8 row_mask:0xf bank_mask:0xf
    v_cndmask_b32_dpp v45, v41, v45, vcc row_ror:8 row_mask:0xf bank_mask:0xf
    v_cndmask_b32_dpp v46, v42, v46, vcc row_ror:8 row_mask:0xf bank_mask:0xf
    v_cndmask_b32_dpp v47, v43, v47, vcc row_ror:8 row_mask:0xf bank_mask:0xf
    s_mov_b64 vcc, s[44:45]
    v_cndmask_b32_dpp v40, v52, v48, vcc row_ror:8 row_mask:0xf bank_mask:0xf
    v_cndmask_b32_dpp v41, v53, v49, vcc row_ror:8 row_mask:0xf bank_mask:0xf
    v_cndmask_b32_dpp v42, v54, v50, vcc row_ror:8 row_mask:0xf bank_mask:0xf
    v_cndmask_b32_dpp v43, v55, v51, vcc row_ror:8 row_mask:0xf bank_mask:0xf
    s_mov_b64 vcc, s[46:47]
    v_cndmask_b32_dpp v52, v48, v52, vcc row_ror:8 row_mask:0xf bank_mask:0xf
    v_cndmask_b32_dpp v53, v49, v53, vcc row_ror:8 row_mask:0xf bank_mask:0xf
    v_cndmask_b32_dpp v54, v50, v54, vcc row_ror:8 row_mask:0xf bank_mask:0xf
    v_cndmask_b32_dpp v55, v51, v55, vcc row_ror:8 row_mask:0xf bank_mask:0xf
    s_mov_b64 vcc, s[44:45]
    v_cndmask_b32_dpp v48, v60, v56, vcc row_ror:8 row_mask:0xf bank_mask:0xf
    v_cndmask_b32_dpp v49, v61, v57, vcc row_ror:8 row_mask:0xf bank_mask:0xf
    v_cndmask_b32_dpp v50, v62, v58, vcc row_ror:8 row_mask:0xf bank_mask:0xf
    v_cndmask_b32_dpp v51, v63, v59, vcc row_ror:8 row_mask:0xf bank_mask:0xf
    s_mov_b64 vcc, s[46:47]
    v_cndmask_b32_dpp v60, v56, v60, vcc row_ror:8 row_mask:0xf bank_mask:0xf
    v_cndmask_b32_dpp v61, v57, v61, vcc row_ror:8 row_mask:0xf bank_mask:0xf
    v_cndmask_b32_dpp v62, v58, v62, vcc row_ror:8 row_mask:0xf bank_mask:0xf
    v_cndmask_b32_dpp v63, v59, v63, vcc row_ror:8 row_mask:0xf bank_mask:0xf
    s_mov_b64 vcc, s[44:45]
    v_cndmask_b32_dpp v56, v68, v64, vcc row_ror:8 row_mask:0xf bank_mask:0xf
    v_cndmask_b32_dpp v57, v69, v65, vcc row_ror:8 row_mask:0xf bank_mask:0xf
    v_cndmask_b32_dpp v58, v70, v66, vcc row_ror:8 row_mask:0xf bank_mask:0xf
    v_cndmask_b32_dpp v59, v71, v67, vcc row_ror:8 row_mask:0xf bank_mask:0xf
    s_mov_b64 vcc, s[46:47]
    v_cndmask_b32_dpp v68, v64, v68, vcc row_ror:8 row_mask:0xf bank_mask:0xf
    v_cndmask_b32_dpp v69, v65, v69, vcc row_ror:8 row_mask:0xf bank_mask:0xf
    v_cndmask_b32_dpp v70, v66, v70, vcc row_ror:8 row_mask:0xf bank_mask:0xf
    v_cndmask_b32_dpp v71, v67, v71, vcc row_ror:8 row_mask:0xf bank_mask:0xf
    s_mov_b64 vcc, s[44:45]
    v_cndmask_b32_dpp v64, v76, v72, vcc row_ror:8 row_mask:0xf bank_mask:0xf
    v_cndmask_b32_dpp v65, v77, v73, vcc row_ror:8 row_mask:0xf bank_mask:0xf
    v_cndmask_b32_dpp v66, v78, v74, vcc row_ror:8 row_mask:0xf bank_mask:0xf
    v_cndmask_b32_dpp v67, v79, v75, vcc row_ror:8 row_mask:0xf bank_mask:0xf
    s_mov_b64 vcc, s[46:47]
    v_cndmask_b32_dpp v76, v72, v76, vcc row_ror:8 row_mask:0xf bank_mask:0xf
    v_cndmask_b32_dpp v77, v73, v77, vcc row_ror:8 row_mask:0xf bank_mask:0xf
    v_cndmask_b32_dpp v78, v74, v78, vcc row_ror:8 row_mask:0xf bank_mask:0xf
    v_cndmask_b32_dpp v79, v75, v79, vcc row_ror:8 row_mask:0xf bank_mask:0xf
    s_mov_b64 vcc, s[44:45]
    v_cndmask_b32_dpp v72, v84, v80, vcc row_ror:8 row_mask:0xf bank_mask:0xf
    v_cndmask_b32_dpp v73, v85, v81, vcc row_ror:8 row_mask:0xf bank_mask:0xf
    v_cndmask_b32_dpp v74, v86, v82, vcc row_ror:8 row_mask:0xf bank_mask:0xf
    v_cndmask_b32_dpp v75, v87, v83, vcc row_ror:8 row_mask:0xf bank_mask:0xf
    s_mov_b64 vcc, s[46:47]
    v_cndmask_b32_dpp v84, v80, v84, vcc row_ror:8 row_mask:0xf bank_mask:0xf
    v_cndmask_b32_dpp v85, v81, v85, vcc row_ror:8 row_mask:0xf bank_mask:0xf
    v_cndmask_b32_dpp v86, v82, v86, vcc row_ror:8 row_mask:0xf bank_mask:0xf
    v_cndmask_b32_dpp v87, v83, v87, vcc row_ror:8 row_mask:0xf bank_mask:0xf
    s_mov_b64 vcc, s[44:45]
    v_cndmask_b32_dpp v80, v92, v88, vcc row_ror:8 row_mask:0xf bank_mask:0xf
    v_cndmask_b32_dpp v81, v93, v89, vcc row_ror:8 row_mask:0xf bank_mask:0xf
    v_cndmask_b32_dpp v82, v94, v90, vcc row_ror:8 row_mask:0xf bank_mask:0xf
    v_cndmask_b32_dpp v83, v95, v91, vcc row_ror:8 row_mask:0xf bank_mask:0xf
    s_mov_b64 vcc, s[46:47]
    v_cndmask_b32_dpp v92, v88, v92, vcc row_ror:8 row_mask:0xf bank_mask:0xf
    v_cndmask_b32_dpp v93, v89, v93, vcc row_ror:8 row_mask:0xf bank_mask:0xf
    v_cndmask_b32_dpp v94, v90, v94, vcc row_ror:8 row_mask:0xf bank_mask:0xf
    v_cndmask_b32_dpp v95, v91, v95, vcc row_ror:8 row_mask:0xf bank_mask:0xf
    s_mov_b64 vcc, s[44:45]
    v_cndmask_b32_dpp v88, v100, v96, vcc row_ror:8 row_mask:0xf bank_mask:0xf
    v_cndmask_b32_dpp v89, v101, v97, vcc row_ror:8 row_mask:0xf bank_mask:0xf
    v_cndmask_b32_dpp v90, v102, v98, vcc row_ror:8 row_mask:0xf bank_mask:0xf
    v_cndmask_b32_dpp v91, v103, v99, vcc row_ror:8 row_mask:0xf bank_mask:0xf
    s_mov_b64 vcc, s[46:47]
    v_cndmask_b32_dpp v100, v96, v100, vcc row_ror:8 row_mask:0xf bank_mask:0xf
    v_cndmask_b32_dpp v101, v97, v101, vcc row_ror:8 row_mask:0xf bank_mask:0xf
    v_cndmask_b32_dpp v102, v98, v102, vcc row_ror:8 row_mask:0xf bank_mask:0xf
    v_cndmask_b32_dpp v103, v99, v103, vcc row_ror:8 row_mask:0xf bank_mask:0xf
    s_mov_b64 vcc, s[44:45]
    v_cndmask_b32_dpp v96, v108, v104, vcc row_ror:8 row_mask:0xf bank_mask:0xf
    v_cndmask_b32_dpp v97, v109, v105, vcc row_ror:8 row_mask:0xf bank_mask:0xf
    v_cndmask_b32_dpp v98, v110, v106, vcc row_ror:8 row_mask:0xf bank_mask:0xf
    v_cndmask_b32_dpp v99, v111, v107, vcc row_ror:8 row_mask:0xf bank_mask:0xf
    s_mov_b64 vcc, s[46:47]
    v_cndmask_b32_dpp v108, v104, v108, vcc row_ror:8 row_mask:0xf bank_mask:0xf
    v_cndmask_b32_dpp v109, v105, v109, vcc row_ror:8 row_mask:0xf bank_mask:0xf
    v_cndmask_b32_dpp v110, v106, v110, vcc row_ror:8 row_mask:0xf bank_mask:0xf
    v_cndmask_b32_dpp v111, v107, v111, vcc row_ror:8 row_mask:0xf bank_mask:0xf
    s_mov_b64 vcc, s[44:45]
    v_cndmask_b32_dpp v104, v116, v112, vcc row_ror:8 row_mask:0xf bank_mask:0xf
    v_cndmask_b32_dpp v105, v117, v113, vcc row_ror:8 row_mask:0xf bank_mask:0xf
    v_cndmask_b32_dpp v106, v118, v114, vcc row_ror:8 row_mask:0xf bank_mask:0xf
    v_cndmask_b32_dpp v107, v119, v115, vcc row_ror:8 row_mask:0xf bank_mask:0xf
    s_mov_b64 vcc, s[46:47]
    v_cndmask_b32_dpp v116, v112, v116, vcc row_ror:8 row_mask:0xf bank_mask:0xf
    v_cndmask_b32_dpp v117, v113, v117, vcc row_ror:8 row_mask:0xf bank_mask:0xf
    v_cndmask_b32_dpp v118, v114, v118, vcc row_ror:8 row_mask:0xf bank_mask:0xf
    v_cndmask_b32_dpp v119, v115, v119, vcc row_ror:8 row_mask:0xf bank_mask:0xf
    s_mov_b64 vcc, s[44:45]
    v_cndmask_b32_dpp v112, v124, v120, vcc row_ror:8 row_mask:0xf bank_mask:0xf
    v_cndmask_b32_dpp v113, v125, v121, vcc row_ror:8 row_mask:0xf bank_mask:0xf
    v_cndmask_b32_dpp v114, v126, v122, vcc row_ror:8 row_mask:0xf bank_mask:0xf
    v_cndmask_b32_dpp v115, v127, v123, vcc row_ror:8 row_mask:0xf bank_mask:0xf
    s_mov_b64 vcc, s[46:47]
    v_cndmask_b32_dpp v124, v120, v124, vcc row_ror:8 row_mask:0xf bank_mask:0xf
    v_cndmask_b32_dpp v125, v121, v125, vcc row_ror:8 row_mask:0xf bank_mask:0xf
    v_cndmask_b32_dpp v126, v122, v126, vcc row_ror:8 row_mask:0xf bank_mask:0xf
    v_cndmask_b32_dpp v127, v123, v127, vcc row_ror:8 row_mask:0xf bank_mask:0xf
    s_mov_b64 vcc, s[44:45]
    v_cndmask_b32_dpp v120, v132, v128, vcc row_ror:8 row_mask:0xf bank_mask:0xf
    v_cndmask_b32_dpp v121, v133, v129, vcc row_ror:8 row_mask:0xf bank_mask:0xf
    v_cndmask_b32_dpp v122, v134, v130, vcc row_ror:8 row_mask:0xf bank_mask:0xf
    v_cndmask_b32_dpp v123, v135, v131, vcc row_ror:8 row_mask:0xf bank_mask:0xf
    s_mov_b64 vcc, s[46:47]
    v_cndmask_b32_dpp v132, v128, v132, vcc row_ror:8 row_mask:0xf bank_mask:0xf
    v_cndmask_b32_dpp v133, v129, v133, vcc row_ror:8 row_mask:0xf bank_mask:0xf
    v_cndmask_b32_dpp v134, v130, v134, vcc row_ror:8 row_mask:0xf bank_mask:0xf
    v_cndmask_b32_dpp v135, v131, v135, vcc row_ror:8 row_mask:0xf bank_mask:0xf
    s_mov_b64 vcc, s[44:45]
    v_cndmask_b32_dpp v128, v140, v136, vcc row_ror:8 row_mask:0xf bank_mask:0xf
    v_cndmask_b32_dpp v129, v141, v137, vcc row_ror:8 row_mask:0xf bank_mask:0xf
    v_cndmask_b32_dpp v130, v142, v138, vcc row_ror:8 row_mask:0xf bank_mask:0xf
    v_cndmask_b32_dpp v131, v143, v139, vcc row_ror:8 row_mask:0xf bank_mask:0xf
    s_mov_b64 vcc, s[46:47]
    v_cndmask_b32_dpp v140, v136, v140, vcc row_ror:8 row_mask:0xf bank_mask:0xf
    v_cndmask_b32_dpp v141, v137, v141, vcc row_ror:8 row_mask:0xf bank_mask:0xf
    v_cndmask_b32_dpp v142, v138, v142, vcc row_ror:8 row_mask:0xf bank_mask:0xf
    v_cndmask_b32_dpp v143, v139, v143, vcc row_ror:8 row_mask:0xf bank_mask:0xf
L_qpoll:
    s_waitcnt vmcnt(0)
    s_add_u32 s62, s62, 1
    v_cmp_ne_u32 vcc, s58, v163
    s_cmp_gt_u32 s62, 0x1000000
    s_cbranch_scc1 L_qpoll_done
    s_nop 3
    s_cbranch_vccz L_qpoll_done
    s_mov_b64 exec, vcc
    s_sleep 3
    s_cmp_lg_u32 s62, 6
    s_cbranch_scc1 L_nocopy
    s_mov_b64 s[98:99], exec
    s_mov_b32 exec_lo, -1
    s_mov_b32 exec_hi, 0
    s_lshl_b32 s60, s56, 3
    s_add_u32 s60, s60, s53
    s_lshl_b32 s60, s60, 12
    s_add_u32 s68, s60, 1048576
    s_add_u32 s100, s68, 4096
L_copyblk:
    s_mov_b32 s61, 0
L_copyown:
    buffer_load_dwordx4 v[4:7], v208, s[28:31], s68 offen sc1
    s_add_u32 s61, s61, 1
    s_waitcnt vmcnt(0)
    v_cmp_ne_u32 vcc, s58, v7
    s_cmp_gt_u32 s61, 0x1000000
    s_cbranch_scc1 L_copyst
    s_nop 3
    s_cbranch_vccnz L_copyown
L_copyst:
    s_xor_b32 s60, s68, 8388608
    buffer_store_dwordx4 v[4:7], v208, s[28:31], s60 offen sc1
    s_add_u32 s68, s68, 1024
    s_cmp_lt_u32 s68, s100
    s_nop 0
    s_cbranch_scc1 L_copyblk
    s_mov_b64 exec, s[98:99]
L_nocopy:
    s_cmp_lt_u32 s62, 6
    s_cselect_b32 s60, 0, 8388608
    s_xor_b32 s63, s63, s60
    s_bitcmp1_b32 s63, 23
    s_cbranch_scc1 L_qldB
    buffer_load_dwordx4 v[160:163], v215, s[28:31], s63 offen nt
    s_branch L_qpoll
L_qldB:
    buffer_load_dwordx4 v[160:163], v215, s[28:31], s63 offen sc1
    s_branch L_qpoll
L_qpoll_done:
    s_mov_b64 exec, -1
    v_lshrrev_b32 v5, 28, v162
    v_cmp_ne_u32 vcc, s71, v5
    v_bfe_u32 v5, v162, 20, 8
    v_add_u32 v5, 0xffffff88, v5
    s_mov_b32 s60, 0x3f802008
    v_ldexp_f32 v5, s60, v5
    v_bfe_i32 v176, v160, 0, 11
    v_bfe_i32 v177, v160, 11, 11
    v_ashrrev_i32 v178, 22, v160
    v_bfe_i32 v179, v161, 0, 11
    v_bfe_i32 v180, v161, 11, 11
    v_ashrrev_i32 v181, 22, v161
    v_bfe_i32 v182, v162, 0, 10
    v_bfe_i32 v183, v162, 10, 10
    v_add_f32 v6, v5, v5
    v_cvt_f32_i32 v176, v176
    v_cvt_f32_i32 v177, v177
    v_cvt_f32_i32 v178, v178
    v_cvt_f32_i32 v179, v179
    v_cvt_f32_i32 v180, v180
    v_cvt_f32_i32 v181, v181
    v_cvt_f32_i32 v182, v182
    v_cvt_f32_i32 v183, v183
    v_mul_f32 v176, v5, v176
    v_mul_f32 v177, v5, v177
    v_mul_f32 v178, v6, v178
    v_mul_f32 v179, v5, v179
    v_mul_f32 v180, v5, v180
    v_mul_f32 v181, v6, v181
    v_mul_f32 v182, v6, v182
    v_mul_f32 v183, v6, v183
    v_cvt_pk_bf16_f32 v144, v176, v177
    v_cvt_pk_bf16_f32 v145, v178, v179
    v_cvt_pk_bf16_f32 v146, v180, v181
    v_cvt_pk_bf16_f32 v147, v182, v183
    s_lshl_b32 s60, s57, 10
    s_add_u32 s60, s60, 147456
    v_add_u32 v7, s60, v208
    s_cmp_lg_u64 vcc, 0
    s_cselect_b32 s70, 0x101, 1
    ds_write_b128 v7, v[144:147]
    s_waitcnt lgkmcnt(0)
    v_mov_b32 v8, 156236
    v_mov_b32 v9, s70
    s_mov_b64 exec, 1
    ds_add_u32 v8, v9
    s_mov_b64 exec, -1
    s_mov_b32 s62, 0
L_syncQ:
    ds_read_b32 v9, v8
    s_add_u32 s62, s62, 1
    s_waitcnt lgkmcnt(0)
    v_readfirstlane_b32 s70, v9
    s_cmp_gt_u32 s62, 0x8000000
    s_cbranch_scc1 L_syncQ_done
    s_and_b32 s60, s70, 0xff
    s_cmp_ge_u32 s60, 4
    s_cbranch_scc0 L_syncQ
L_syncQ_done:
    s_lshr_b32 s70, s70, 8
    s_cmp_eq_u32 s70, 0
    s_cbranch_scc1 L_norepub
    s_lshl_b32 s60, s56, 3
    s_add_u32 s60, s60, s53
    s_lshl_b32 s60, s60, 12
    s_lshl_b32 s61, s57, 10
    s_add_u32 s60, s60, s61
    s_add_u32 s68, s60, 1048576
    s_mov_b32 exec_hi, 0
    s_mov_b32 s61, 0
L_repub:
    buffer_load_dwordx4 v[4:7], v208, s[28:31], s68 offen sc1
    s_add_u32 s61, s61, 1
    s_waitcnt vmcnt(0)
    v_cmp_ne_u32 vcc, s58, v7
    s_cmp_gt_u32 s61, 0x1000000
    s_cbranch_scc1 L_repubst
    s_nop 3
    s_cbranch_vccnz L_repub
L_repubst:
    s_xor_b32 s68, s68, 8388608
    buffer_store_dwordx4 v[4:7], v208, s[28:31], s68 offen sc1
    s_mov_b64 exec, -1
    s_nop 0
L_norepub:
    v_add_u32 v7, 147456, v208
    ds_read_b128 v[144:147], v7 offset:0
    ds_read_b128 v[148:151], v7 offset:1024
    ds_read_b128 v[152:155], v7 offset:2048
    ds_read_b128 v[156:159], v7 offset:3072
    s_waitcnt lgkmcnt(0)
    v_mfma_f32_16x16x32_bf16 v[176:179], v[12:15], v[144:147], 0
    v_mfma_f32_16x16x32_bf16 v[180:183], v[24:27], v[144:147], 0
    v_mfma_f32_16x16x32_bf16 v[184:187], v[40:43], v[144:147], 0
    v_mfma_f32_16x16x32_bf16 v[188:191], v[56:59], v[144:147], 0
    v_mfma_f32_16x16x32_bf16 v[192:195], v[72:75], v[144:147], 0
    v_mfma_f32_16x16x32_bf16 v[196:199], v[88:91], v[144:147], 0
    v_mfma_f32_16x16x32_bf16 v[200:203], v[104:107], v[144:147], 0
    v_mfma_f32_16x16x32_bf16 v[204:207], v[120:123], v[144:147], 0
    v_mfma_f32_16x16x32_bf16 v[176:179], v[20:23], v[148:151], v[176:179]
    v_mfma_f32_16x16x32_bf16 v[180:183], v[36:39], v[148:151], v[180:183]
    v_mfma_f32_16x16x32_bf16 v[184:187], v[52:55], v[148:151], v[184:187]
    v_mfma_f32_16x16x32_bf16 v[188:191], v[68:71], v[148:151], v[188:191]
    v_mfma_f32_16x16x32_bf16 v[192:195], v[84:87], v[148:151], v[192:195]
    v_mfma_f32_16x16x32_bf16 v[196:199], v[100:103], v[148:151], v[196:199]
    v_mfma_f32_16x16x32_bf16 v[200:203], v[116:119], v[148:151], v[200:203]
    v_mfma_f32_16x16x32_bf16 v[204:207], v[132:135], v[148:151], v[204:207]
    v_mfma_f32_16x16x32_bf16 v[176:179], v[16:19], v[152:155], v[176:179]
    v_mfma_f32_16x16x32_bf16 v[180:183], v[32:35], v[152:155], v[180:183]
    v_mfma_f32_16x16x32_bf16 v[184:187], v[48:51], v[152:155], v[184:187]
    v_mfma_f32_16x16x32_bf16 v[188:191], v[64:67], v[152:155], v[188:191]
    v_mfma_f32_16x16x32_bf16 v[192:195], v[80:83], v[152:155], v[192:195]
    v_mfma_f32_16x16x32_bf16 v[196:199], v[96:99], v[152:155], v[196:199]
    v_mfma_f32_16x16x32_bf16 v[200:203], v[112:115], v[152:155], v[200:203]
    v_mfma_f32_16x16x32_bf16 v[204:207], v[128:131], v[152:155], v[204:207]
    v_mfma_f32_16x16x32_bf16 v[176:179], v[28:31], v[156:159], v[176:179]
    v_mfma_f32_16x16x32_bf16 v[180:183], v[44:47], v[156:159], v[180:183]
    v_mfma_f32_16x16x32_bf16 v[184:187], v[60:63], v[156:159], v[184:187]
    v_mfma_f32_16x16x32_bf16 v[188:191], v[76:79], v[156:159], v[188:191]
    v_mfma_f32_16x16x32_bf16 v[192:195], v[92:95], v[156:159], v[192:195]
    v_mfma_f32_16x16x32_bf16 v[196:199], v[108:111], v[156:159], v[196:199]
    v_mfma_f32_16x16x32_bf16 v[200:203], v[124:127], v[156:159], v[200:203]
    v_mfma_f32_16x16x32_bf16 v[204:207], v[140:143], v[156:159], v[204:207]
    s_lshl_b32 s60, s57, 6
    s_add_u32 s60, s60, 155648
    v_lshlrev_b32 v7, 2, v1
    v_add_u32 v8, s60, v7
    s_mov_b32 s59, 0x3e0293ee
    s_nop 3
    v_max3_f32 v5, v176, v177, v178
    v_max3_f32 v6, v179, v180, v181
    v_max3_f32 v5, v5, v182, v183
    v_max3_f32 v6, v6, v184, v185
    v_max3_f32 v5, v5, v186, v187
    v_max3_f32 v6, v6, v188, v189
    v_max3_f32 v5, v5, v190, v191
    v_max3_f32 v6, v6, v192, v193
    v_max3_f32 v5, v5, v194, v195
    v_max3_f32 v6, v6, v196, v197
    v_max3_f32 v5, v5, v198, v199
    v_max3_f32 v6, v6, v200, v201
    v_max3_f32 v5, v5, v202, v203
    v_max3_f32 v6, v6, v204, v205
    v_max3_f32 v5, v5, v206, v207
    v_max_f32 v5, v5, v6
    v_mov_b32 v6, v5
    s_nop 1
    v_permlane32_swap_b32 v5, v6
    v_max_f32 v5, v5, v6
    v_mov_b32 v6, v5
    s_nop 1
    v_permlane16_swap_b32 v5, v6
    v_max_f32 v5, v5, v6
    ds_write_b32 v8, v5
    s_waitcnt lgkmcnt(0)
    v_mov_b32 v100, 156228
    v_mov_b32 v101, 1
    s_mov_b64 exec, 1
    ds_add_u32 v100, v101
    s_mov_b64 exec, -1
    v_mov_b32 v100, 156228
    s_mov_b32 s62, 0
L_syncC:
    ds_read_b32 v101, v100
    s_add_u32 s62, s62, 1
    s_waitcnt lgkmcnt(0)
    v_readfirstlane_b32 s60, v101
    s_cmp_gt_u32 s62, 0x8000000
    s_cbranch_scc1 L_syncC_done
    s_cmp_ge_u32 s60, 4
    s_cbranch_scc1 L_syncC_done
    s_branch L_syncC
L_syncC_done:
    v_add_u32 v9, 155648, v7
    ds_read_b32 v10, v9
    ds_read_b32 v11, v9 offset:64
    ds_read_b32 v12, v9 offset:128
    ds_read_b32 v13, v9 offset:192
    s_waitcnt lgkmcnt(0)
    v_max3_f32 v10, v10, v11, v12
    v_max_f32 v10, v10, v13
    v_mul_f32 v10, s59, v10
    v_add_u32 v9, 156160, v7
    ds_write_b32 v9, v10
    v_fma_f32 v176, v176, s59, -v10
    v_fma_f32 v177, v177, s59, -v10
    v_fma_f32 v178, v178, s59, -v10
    v_fma_f32 v179, v179, s59, -v10
    v_fma_f32 v180, v180, s59, -v10
    v_fma_f32 v181, v181, s59, -v10
    v_fma_f32 v182, v182, s59, -v10
    v_fma_f32 v183, v183, s59, -v10
    v_fma_f32 v184, v184, s59, -v10
    v_fma_f32 v185, v185, s59, -v10
    v_fma_f32 v186, v186, s59, -v10
    v_fma_f32 v187, v187, s59, -v10
    v_fma_f32 v188, v188, s59, -v10
    v_fma_f32 v189, v189, s59, -v10
    v_fma_f32 v190, v190, s59, -v10
    v_fma_f32 v191, v191, s59, -v10
    v_fma_f32 v192, v192, s59, -v10
    v_fma_f32 v193, v193, s59, -v10
    v_fma_f32 v194, v194, s59, -v10
    v_fma_f32 v195, v195, s59, -v10
    v_fma_f32 v196, v196, s59, -v10
    v_fma_f32 v197, v197, s59, -v10
    v_fma_f32 v198, v198, s59, -v10
    v_fma_f32 v199, v199, s59, -v10
    v_fma_f32 v200, v200, s59, -v10
    v_fma_f32 v201, v201, s59, -v10
    v_fma_f32 v202, v202, s59, -v10
    v_fma_f32 v203, v203, s59, -v10
    v_fma_f32 v204, v204, s59, -v10
    v_fma_f32 v205, v205, s59, -v10
    v_fma_f32 v206, v206, s59, -v10
    v_fma_f32 v207, v207, s59, -v10
    v_exp_f32 v176, v176
    v_exp_f32 v177, v177
    v_exp_f32 v178, v178
    v_exp_f32 v179, v179
    v_exp_f32 v180, v180
    v_exp_f32 v181, v181
    v_exp_f32 v182, v182
    v_exp_f32 v183, v183
    v_exp_f32 v184, v184
    v_exp_f32 v185, v185
    v_exp_f32 v186, v186
    v_exp_f32 v187, v187
    v_exp_f32 v188, v188
    v_exp_f32 v189, v189
    v_exp_f32 v190, v190
    v_exp_f32 v191, v191
    v_exp_f32 v192, v192
    v_exp_f32 v193, v193
    v_exp_f32 v194, v194
    v_exp_f32 v195, v195
    v_exp_f32 v196, v196
    v_exp_f32 v197, v197
    v_exp_f32 v198, v198
    v_exp_f32 v199, v199
    v_exp_f32 v200, v200
    v_exp_f32 v201, v201
    v_exp_f32 v202, v202
    v_exp_f32 v203, v203
    v_exp_f32 v204, v204
    v_exp_f32 v205, v205
    v_exp_f32 v206, v206
    v_exp_f32 v207, v207
    s_nop 0
    v_add_f32 v5, v176, v177
    v_add_f32 v6, v178, v179
    v_add_f32 v5, v5, v180
    v_add_f32 v6, v6, v181
    v_add_f32 v5, v5, v182
    v_add_f32 v6, v6, v183
    v_add_f32 v5, v5, v184
    v_add_f32 v6, v6, v185
    v_add_f32 v5, v5, v186
    v_add_f32 v6, v6, v187
    v_add_f32 v5, v5, v188
    v_add_f32 v6, v6, v189
    v_add_f32 v5, v5, v190
    v_add_f32 v6, v6, v191
    v_add_f32 v5, v5, v192
    v_add_f32 v6, v6, v193
    v_add_f32 v5, v5, v194
    v_add_f32 v6, v6, v195
    v_add_f32 v5, v5, v196
    v_add_f32 v6, v6, v197
    v_add_f32 v5, v5, v198
    v_add_f32 v6, v6, v199
    v_add_f32 v5, v5, v200
    v_add_f32 v6, v6, v201
    v_add_f32 v5, v5, v202
    v_add_f32 v6, v6, v203
    v_add_f32 v5, v5, v204
    v_add_f32 v6, v6, v205
    v_add_f32 v5, v5, v206
    v_add_f32 v6, v6, v207
    v_cvt_pk_bf16_f32 v160, v176, v177
    v_cvt_pk_bf16_f32 v161, v178, v179
    v_cvt_pk_bf16_f32 v162, v180, v181
    v_cvt_pk_bf16_f32 v163, v182, v183
    v_cvt_pk_bf16_f32 v164, v184, v185
    v_cvt_pk_bf16_f32 v165, v186, v187
    v_cvt_pk_bf16_f32 v166, v188, v189
    v_cvt_pk_bf16_f32 v167, v190, v191
    v_cvt_pk_bf16_f32 v168, v192, v193
    v_cvt_pk_bf16_f32 v169, v194, v195
    v_cvt_pk_bf16_f32 v170, v196, v197
    v_cvt_pk_bf16_f32 v171, v198, v199
    v_cvt_pk_bf16_f32 v172, v200, v201
    v_cvt_pk_bf16_f32 v173, v202, v203
    v_cvt_pk_bf16_f32 v174, v204, v205
    v_cvt_pk_bf16_f32 v175, v206, v207
    v_add_f32 v5, v5, v6
    v_mov_b32 v6, v5
    s_lshl_b32 s60, s57, 10
    s_add_u32 s60, s60, 131072
    v_permlane32_swap_b32 v5, v6
    v_add_u32 v11, s60, v208
    v_add_f32 v5, v5, v6
    v_mov_b32 v6, v5
    s_nop 1
    v_permlane16_swap_b32 v5, v6
    v_add_f32 v5, v5, v6
    v_add_u32 v8, 256, v8
    ds_write_b32 v8, v5
    ds_write_b128 v11, v[160:163] offset:0
    ds_write_b128 v11, v[164:167] offset:4096
    ds_write_b128 v11, v[168:171] offset:8192
    ds_write_b128 v11, v[172:175] offset:12288
    v_bfe_u32 v3, v0, 2, 2
    v_and_b32 v4, 1, v2
    v_lshl_add_u32 v3, v4, 2, v3
    v_lshrrev_b32 v4, 1, v2
    v_lshl_add_u32 v4, v4, 4, v3
    v_lshlrev_b32 v4, 8, v4
    v_and_b32 v5, 3, v0
    v_lshl_add_u32 v4, v5, 3, v4
    s_lshl_b32 s60, s57, 1
    v_xor_b32 v5, s60, v3
    v_lshl_add_u32 v120, v5, 5, v4
    v_xor_b32 v5, 1, v5
    v_lshl_add_u32 v121, v5, 5, v4
    v_add_u32 v122, 65536, v120
    v_add_u32 v123, 65536, v121
    v_add_u32 v6, 131072, v208
    v_mov_b32 v124, 0
    v_mov_b32 v125, 0
    v_mov_b32 v126, 0
    v_mov_b32 v127, 0
    s_waitcnt lgkmcnt(0)
    s_setprio 0
    s_cmp_lg_u32 s70, 0
    s_cbranch_scc1 L_nopre
    buffer_store_dwordx4 v[124:127], v208, s[28:31], s48 offen
L_nopre:
    s_barrier
    ds_read_b128 v[16:19], v6 offset:0
    ds_read_b64_tr_b16 v[48:49], v120 offset:0
    ds_read_b64_tr_b16 v[50:51], v120 offset:2048
    ds_read_b64_tr_b16 v[52:53], v121 offset:0
    ds_read_b64_tr_b16 v[54:55], v121 offset:2048
    ds_read_b128 v[20:23], v6 offset:1024
    ds_read_b64_tr_b16 v[56:57], v120 offset:8192
    ds_read_b64_tr_b16 v[58:59], v120 offset:10240
    ds_read_b64_tr_b16 v[60:61], v121 offset:8192
    ds_read_b64_tr_b16 v[62:63], v121 offset:10240
    ds_read_b128 v[24:27], v6 offset:2048
    ds_read_b64_tr_b16 v[64:65], v120 offset:16384
    ds_read_b64_tr_b16 v[66:67], v120 offset:18432
    ds_read_b64_tr_b16 v[68:69], v121 offset:16384
    ds_read_b64_tr_b16 v[70:71], v121 offset:18432
    ds_read_b128 v[28:31], v6 offset:3072
    ds_read_b64_tr_b16 v[72:73], v120 offset:24576
    ds_read_b64_tr_b16 v[74:75], v120 offset:26624
    ds_read_b64_tr_b16 v[76:77], v121 offset:24576
    ds_read_b64_tr_b16 v[78:79], v121 offset:26624
    ds_read_b128 v[32:35], v6 offset:4096
    ds_read_b64_tr_b16 v[80:81], v120 offset:32768
    ds_read_b64_tr_b16 v[82:83], v120 offset:34816
    ds_read_b64_tr_b16 v[84:85], v121 offset:32768
    ds_read_b64_tr_b16 v[86:87], v121 offset:34816
    ds_read_b128 v[36:39], v6 offset:5120
    ds_read_b64_tr_b16 v[88:89], v120 offset:40960
    ds_read_b64_tr_b16 v[90:91], v120 offset:43008
    ds_read_b64_tr_b16 v[92:93], v121 offset:40960
    ds_read_b64_tr_b16 v[94:95], v121 offset:43008
    ds_read_b128 v[40:43], v6 offset:6144
    ds_read_b64_tr_b16 v[96:97], v120 offset:49152
    ds_read_b64_tr_b16 v[98:99], v120 offset:51200
    ds_read_b64_tr_b16 v[100:101], v121 offset:49152
    ds_read_b64_tr_b16 v[102:103], v121 offset:51200
    ds_read_b128 v[44:47], v6 offset:7168
    ds_read_b64_tr_b16 v[104:105], v120 offset:57344
    ds_read_b64_tr_b16 v[106:107], v120 offset:59392
    ds_read_b64_tr_b16 v[108:109], v121 offset:57344
    ds_read_b64_tr_b16 v[110:111], v121 offset:59392
    s_waitcnt lgkmcnt(0)
    v_mfma_f32_16x16x32_bf16 v[112:115], v[48:51], v[16:19], 0
    v_mfma_f32_16x16x32_bf16 v[116:119], v[52:55], v[16:19], 0
    v_mfma_f32_16x16x32_bf16 v[112:115], v[56:59], v[20:23], v[112:115]
    v_mfma_f32_16x16x32_bf16 v[116:119], v[60:63], v[20:23], v[116:119]
    v_mfma_f32_16x16x32_bf16 v[112:115], v[64:67], v[24:27], v[112:115]
    v_mfma_f32_16x16x32_bf16 v[116:119], v[68:71], v[24:27], v[116:119]
    v_mfma_f32_16x16x32_bf16 v[112:115], v[72:75], v[28:31], v[112:115]
    v_mfma_f32_16x16x32_bf16 v[116:119], v[76:79], v[28:31], v[116:119]
    v_mfma_f32_16x16x32_bf16 v[112:115], v[80:83], v[32:35], v[112:115]
    v_mfma_f32_16x16x32_bf16 v[116:119], v[84:87], v[32:35], v[116:119]
    v_mfma_f32_16x16x32_bf16 v[112:115], v[88:91], v[36:39], v[112:115]
    v_mfma_f32_16x16x32_bf16 v[116:119], v[92:95], v[36:39], v[116:119]
    v_mfma_f32_16x16x32_bf16 v[112:115], v[96:99], v[40:43], v[112:115]
    v_mfma_f32_16x16x32_bf16 v[116:119], v[100:103], v[40:43], v[116:119]
    v_mfma_f32_16x16x32_bf16 v[112:115], v[104:107], v[44:47], v[112:115]
    v_mfma_f32_16x16x32_bf16 v[116:119], v[108:111], v[44:47], v[116:119]
    v_add_u32 v8, 155904, v7
    ds_read_b32 v10, v8
    ds_read_b32 v11, v8 offset:64
    ds_read_b32 v12, v8 offset:128
    ds_read_b32 v13, v8 offset:192
    v_add_u32 v8, 156160, v7
    ds_read_b32 v14, v8
    s_waitcnt lgkmcnt(0)
    s_barrier
    v_add_f32 v10, v10, v11
    v_add_f32 v12, v12, v13
    v_add_f32 v10, v10, v12
    v_mov_b32 v128, v14
    v_mov_b32 v129, v10
    v_mov_b32 v130, s58
    v_mov_b32 v131, 0
    v_mov_b32 v127, s58
    s_cmp_lg_u32 s57, 0
    s_cbranch_scc1 L_nostat
    s_mov_b64 exec, 0xffff
    s_cmp_lg_u32 s70, 0
    s_cbranch_scc1 L_stat_remote
    buffer_store_dwordx4 v[128:131], v208, s[28:31], s90 offen
    s_branch L_stat_done
L_stat_remote:
    buffer_store_dwordx4 v[128:131], v208, s[28:31], s90 offen sc1
L_stat_done:
    s_mov_b64 exec, -1
L_nostat:
    s_barrier
    ds_read_b128 v[16:19], v6 offset:8192
    ds_read_b64_tr_b16 v[48:49], v122 offset:0
    ds_read_b64_tr_b16 v[50:51], v122 offset:2048
    ds_read_b64_tr_b16 v[52:53], v123 offset:0
    ds_read_b64_tr_b16 v[54:55], v123 offset:2048
    ds_read_b128 v[20:23], v6 offset:9216
    ds_read_b64_tr_b16 v[56:57], v122 offset:8192
    ds_read_b64_tr_b16 v[58:59], v122 offset:10240
    ds_read_b64_tr_b16 v[60:61], v123 offset:8192
    ds_read_b64_tr_b16 v[62:63], v123 offset:10240
    ds_read_b128 v[24:27], v6 offset:10240
    ds_read_b64_tr_b16 v[64:65], v122 offset:16384
    ds_read_b64_tr_b16 v[66:67], v122 offset:18432
    ds_read_b64_tr_b16 v[68:69], v123 offset:16384
    ds_read_b64_tr_b16 v[70:71], v123 offset:18432
    ds_read_b128 v[28:31], v6 offset:11264
    ds_read_b64_tr_b16 v[72:73], v122 offset:24576
    ds_read_b64_tr_b16 v[74:75], v122 offset:26624
    ds_read_b64_tr_b16 v[76:77], v123 offset:24576
    ds_read_b64_tr_b16 v[78:79], v123 offset:26624
    ds_read_b128 v[32:35], v6 offset:12288
    ds_read_b64_tr_b16 v[80:81], v122 offset:32768
    ds_read_b64_tr_b16 v[82:83], v122 offset:34816
    ds_read_b64_tr_b16 v[84:85], v123 offset:32768
    ds_read_b64_tr_b16 v[86:87], v123 offset:34816
    ds_read_b128 v[36:39], v6 offset:13312
    ds_read_b64_tr_b16 v[88:89], v122 offset:40960
    ds_read_b64_tr_b16 v[90:91], v122 offset:43008
    ds_read_b64_tr_b16 v[92:93], v123 offset:40960
    ds_read_b64_tr_b16 v[94:95], v123 offset:43008
    s_waitcnt lgkmcnt(0)
    v_mfma_f32_16x16x32_bf16 v[112:115], v[48:51], v[16:19], v[112:115]
    v_mfma_f32_16x16x32_bf16 v[116:119], v[52:55], v[16:19], v[116:119]
    v_mfma_f32_16x16x32_bf16 v[112:115], v[56:59], v[20:23], v[112:115]
    v_mfma_f32_16x16x32_bf16 v[116:119], v[60:63], v[20:23], v[116:119]
    v_mfma_f32_16x16x32_bf16 v[112:115], v[64:67], v[24:27], v[112:115]
    v_mfma_f32_16x16x32_bf16 v[116:119], v[68:71], v[24:27], v[116:119]
    v_mfma_f32_16x16x32_bf16 v[112:115], v[72:75], v[28:31], v[112:115]
    v_mfma_f32_16x16x32_bf16 v[116:119], v[76:79], v[28:31], v[116:119]
    v_mfma_f32_16x16x32_bf16 v[112:115], v[80:83], v[32:35], v[112:115]
    v_mfma_f32_16x16x32_bf16 v[116:119], v[84:87], v[32:35], v[116:119]
    v_mfma_f32_16x16x32_bf16 v[112:115], v[88:91], v[36:39], v[112:115]
    v_mfma_f32_16x16x32_bf16 v[116:119], v[92:95], v[36:39], v[116:119]
    ds_read_b128 v[16:19], v6 offset:14336
    ds_read_b128 v[20:23], v6 offset:15360
    s_barrier
    ds_read_b64_tr_b16 v[48:49], v122 offset:49152
    ds_read_b64_tr_b16 v[50:51], v122 offset:51200
    ds_read_b64_tr_b16 v[52:53], v123 offset:49152
    ds_read_b64_tr_b16 v[54:55], v123 offset:51200
    ds_read_b64_tr_b16 v[56:57], v122 offset:57344
    ds_read_b64_tr_b16 v[58:59], v122 offset:59392
    ds_read_b64_tr_b16 v[60:61], v123 offset:57344
    ds_read_b64_tr_b16 v[62:63], v123 offset:59392
    s_waitcnt lgkmcnt(0)
    v_mfma_f32_16x16x32_bf16 v[112:115], v[48:51], v[16:19], v[112:115]
    v_mfma_f32_16x16x32_bf16 v[116:119], v[52:55], v[16:19], v[116:119]
    v_mfma_f32_16x16x32_bf16 v[112:115], v[56:59], v[20:23], v[112:115]
    v_mfma_f32_16x16x32_bf16 v[116:119], v[60:63], v[20:23], v[116:119]
    s_mov_b32 s63, 0x3f7fc000
    s_mov_b32 s68, 0x4b400000
    s_mov_b32 s69, 0x7ff
    s_mov_b32 s61, 0x3fffff
    s_cmp_lg_u32 s70, 0
    s_nop 2
    v_max3_f32 v9, abs(v112), abs(v113), abs(v114)
    v_max3_f32 v10, abs(v115), abs(v116), abs(v117)
    v_max3_f32 v9, v9, abs(v118), abs(v119)
    v_max_f32 v9, v9, v10
    v_frexp_exp_i32_f32 v9, v9
    v_max_i32 v9, 0xffffff9c, v9
    v_sub_u32 v10, 10, v9
    v_ldexp_f32 v10, s63, v10
    v_add_u32 v9, 110, v9
    v_mul_f32 v11, 0.5, v10
    v_fma_f32 v12, v112, v10, s68
    v_fma_f32 v13, v113, v10, s68
    v_fma_f32 v14, v114, v11, s68
    v_fma_f32 v15, v115, v10, s68
    v_fma_f32 v16, v116, v10, s68
    v_fma_f32 v17, v117, v11, s68
    v_fma_f32 v18, v118, v10, s68
    v_fma_f32 v19, v119, v10, s68
    v_lshlrev_b32 v13, 11, v13
    v_lshlrev_b32 v14, 22, v14
    v_lshlrev_b32 v16, 11, v16
    v_lshlrev_b32 v17, 22, v17
    v_lshlrev_b32 v19, 11, v19
    v_lshlrev_b32 v9, 22, v9
    v_bfi_b32 v12, s69, v12, v13
    v_bfi_b32 v15, s69, v15, v16
    v_bfi_b32 v18, s69, v18, v19
    v_bfi_b32 v124, s61, v12, v14
    v_bfi_b32 v125, s61, v15, v17
    v_bfi_b32 v126, s61, v18, v9
    s_cbranch_scc1 L_ostore_remote
    buffer_store_dwordx4 v[124:127], v208, s[28:31], s48 offen
    s_branch L_join2
L_ostore_remote:
    buffer_store_dwordx4 v[124:127], v208, s[28:31], s48 offen sc1
L_join2:
    s_cmp_lg_u32 s70, 0
    s_cbranch_scc1 L_orem1
    buffer_load_dwordx4 v[16:19], v209, s[28:31], s49 offen nt
    buffer_load_dwordx4 v[20:23], v209, s[28:31], s50 offen nt
    buffer_load_dwordx4 v[24:27], v216, s[28:31], s91 offen nt
    buffer_load_dwordx4 v[28:31], v216, s[28:31], s92 offen nt
    s_branch L_odone1
L_orem1:
    buffer_load_dwordx4 v[16:19], v209, s[28:31], s49 offen sc1
    buffer_load_dwordx4 v[20:23], v209, s[28:31], s50 offen sc1
    buffer_load_dwordx4 v[24:27], v216, s[28:31], s91 offen sc1
    buffer_load_dwordx4 v[28:31], v216, s[28:31], s92 offen sc1
L_odone1:
    s_branch L_join3
L_join2L:
    s_cmp_lg_u32 s70, 0
    s_cbranch_scc1 L_orem2
    buffer_load_dwordx4 v[16:19], v209, s[28:31], s49 offen nt
    buffer_load_dwordx4 v[20:23], v209, s[28:31], s50 offen nt
    buffer_load_dwordx4 v[24:27], v216, s[28:31], s91 offen nt
    buffer_load_dwordx4 v[28:31], v216, s[28:31], s92 offen nt
    s_branch L_odone2
L_orem2:
    buffer_load_dwordx4 v[16:19], v209, s[28:31], s49 offen sc1
    buffer_load_dwordx4 v[20:23], v209, s[28:31], s50 offen sc1
    buffer_load_dwordx4 v[24:27], v216, s[28:31], s91 offen sc1
    buffer_load_dwordx4 v[28:31], v216, s[28:31], s92 offen sc1
L_odone2:
    s_waitcnt vmcnt(4)
L_join3:
    s_barrier
    ds_read_b64_tr_b16 v[136:137], v210 offset:0
    ds_read_b64_tr_b16 v[138:139], v210 offset:4096
    ds_read_b64_tr_b16 v[140:141], v210 offset:8192
    ds_read_b64_tr_b16 v[142:143], v210 offset:12288
    ds_read_b64_tr_b16 v[144:145], v210 offset:16384
    ds_read_b64_tr_b16 v[146:147], v210 offset:20480
    ds_read_b64_tr_b16 v[148:149], v210 offset:24576
    ds_read_b64_tr_b16 v[150:151], v210 offset:28672
    ds_read_b64_tr_b16 v[152:153], v210 offset:32768
    ds_read_b64_tr_b16 v[154:155], v210 offset:36864
    ds_read_b64_tr_b16 v[156:157], v210 offset:40960
    ds_read_b64_tr_b16 v[158:159], v210 offset:45056
    ds_read_b64_tr_b16 v[160:161], v210 offset:49152
    ds_read_b64_tr_b16 v[162:163], v210 offset:53248
    ds_read_b64_tr_b16 v[164:165], v210 offset:57344
    ds_read_b64_tr_b16 v[166:167], v210 offset:61440
    s_mov_b32 s62, 0
L_opoll:
    s_waitcnt vmcnt(0)
    v_xor_b32 v9, s58, v19
    v_xor_b32 v10, s58, v23
    v_xor_b32 v11, s58, v26
    v_xor_b32 v12, s58, v30
    v_or3_b32 v9, v9, v10, v11
    v_or_b32 v9, v9, v12
    v_cmp_ne_u32 vcc, 0, v9
    s_add_u32 s62, s62, 1
    s_cmp_gt_u32 s62, 0x1000000
    s_cbranch_scc1 L_opoll_done
    s_nop 3
    s_cbranch_vccz L_opoll_done
    s_mov_b64 exec, vcc
    s_cmp_lg_u32 s70, 0
    s_cbranch_scc1 L_orem3
    buffer_load_dwordx4 v[16:19], v209, s[28:31], s49 offen nt
    buffer_load_dwordx4 v[20:23], v209, s[28:31], s50 offen nt
    buffer_load_dwordx4 v[24:27], v216, s[28:31], s91 offen nt
    buffer_load_dwordx4 v[28:31], v216, s[28:31], s92 offen nt
    s_branch L_odone3
L_orem3:
    buffer_load_dwordx4 v[16:19], v209, s[28:31], s49 offen sc1
    buffer_load_dwordx4 v[20:23], v209, s[28:31], s50 offen sc1
    buffer_load_dwordx4 v[24:27], v216, s[28:31], s91 offen sc1
    buffer_load_dwordx4 v[28:31], v216, s[28:31], s92 offen sc1
L_odone3:
    s_branch L_opoll
L_opoll_done:
    s_mov_b64 exec, -1
    v_max_f32 v9, v24, v28
    v_sub_f32 v10, v24, v9
    v_sub_f32 v11, v28, v9
    v_exp_f32 v10, v10
    v_exp_f32 v11, v11
    v_lshrrev_b32 v13, 22, v18
    v_mul_f32 v12, v10, v25
    v_fma_f32 v12, v11, v29, v12
    v_rcp_f32 v12, v12
    v_lshrrev_b32 v14, 22, v22
    v_add_u32 v13, 0xffffff88, v13
    v_add_u32 v14, 0xffffff88, v14
    v_bfe_i32 v32, v16, 0, 11
    v_bfe_i32 v33, v16, 11, 11
    v_ashrrev_i32 v34, 22, v16
    v_bfe_i32 v35, v17, 0, 11
    v_bfe_i32 v36, v17, 11, 11
    v_ashrrev_i32 v37, 22, v17
    v_bfe_i32 v38, v18, 0, 11
    v_bfe_i32 v39, v18, 11, 11
    v_bfe_i32 v40, v20, 0, 11
    v_bfe_i32 v41, v20, 11, 11
    v_ashrrev_i32 v42, 22, v20
    v_bfe_i32 v43, v21, 0, 11
    v_bfe_i32 v44, v21, 11, 11
    v_ashrrev_i32 v45, 22, v21
    v_bfe_i32 v46, v22, 0, 11
    v_bfe_i32 v47, v22, 11, 11
    v_mul_f32 v12, 0x3f802008, v12
    v_mul_f32 v10, v10, v12
    v_mul_f32 v11, v11, v12
    v_ldexp_f32 v10, v10, v13
    v_ldexp_f32 v11, v11, v14
    v_cvt_f32_i32 v32, v32
    v_cvt_f32_i32 v33, v33
    v_cvt_f32_i32 v34, v34
    v_cvt_f32_i32 v35, v35
    v_cvt_f32_i32 v36, v36
    v_cvt_f32_i32 v37, v37
    v_cvt_f32_i32 v38, v38
    v_cvt_f32_i32 v39, v39
    v_cvt_f32_i32 v40, v40
    v_cvt_f32_i32 v41, v41
    v_cvt_f32_i32 v42, v42
    v_cvt_f32_i32 v43, v43
    v_cvt_f32_i32 v44, v44
    v_cvt_f32_i32 v45, v45
    v_cvt_f32_i32 v46, v46
    v_cvt_f32_i32 v47, v47
    v_add_f32 v13, v10, v10
    v_add_f32 v14, v11, v11
    v_mul_f32 v32, v10, v32
    v_mul_f32 v33, v10, v33
    v_mul_f32 v34, v13, v34
    v_mul_f32 v35, v10, v35
    v_mul_f32 v36, v10, v36
    v_mul_f32 v37, v13, v37
    v_mul_f32 v38, v10, v38
    v_mul_f32 v39, v10, v39
    v_fma_f32 v32, v11, v40, v32
    v_fma_f32 v33, v11, v41, v33
    v_fma_f32 v34, v14, v42, v34
    v_fma_f32 v35, v11, v43, v35
    v_fma_f32 v36, v11, v44, v36
    v_fma_f32 v37, v14, v45, v37
    v_fma_f32 v38, v11, v46, v38
    v_fma_f32 v39, v11, v47, v39
    v_cvt_pk_bf16_f32 v48, v32, v33
    v_cvt_pk_bf16_f32 v49, v34, v35
    v_cvt_pk_bf16_f32 v50, v36, v37
    v_cvt_pk_bf16_f32 v51, v38, v39
    ds_write_b128 v213, v[48:51]
    s_mov_b32 s63, 0x05030201
    s_mov_b32 s68, 0x06050302
    s_mov_b32 s69, 0x07060503
    v_mov_b32 v87, s58
    s_waitcnt lgkmcnt(0)
    s_barrier
    ds_read_b128 v[16:19], v214 offset:0
    ds_read_b128 v[20:23], v214 offset:1024
    ds_read_b128 v[24:27], v214 offset:2048
    ds_read_b128 v[28:31], v214 offset:3072
    ds_read_b128 v[32:35], v214 offset:4096
    ds_read_b128 v[36:39], v214 offset:5120
    ds_read_b128 v[40:43], v214 offset:6144
    ds_read_b128 v[44:47], v214 offset:7168
    s_waitcnt lgkmcnt(7)
    v_mfma_f32_16x16x32_bf16 v[80:83], v[136:139], v[16:19], 0
    s_waitcnt lgkmcnt(6)
    v_mfma_f32_16x16x32_bf16 v[88:91], v[140:143], v[20:23], 0
    s_waitcnt lgkmcnt(5)
    v_mfma_f32_16x16x32_bf16 v[80:83], v[144:147], v[24:27], v[80:83]
    s_waitcnt lgkmcnt(4)
    v_mfma_f32_16x16x32_bf16 v[88:91], v[148:151], v[28:31], v[88:91]
    s_waitcnt lgkmcnt(3)
    v_mfma_f32_16x16x32_bf16 v[80:83], v[152:155], v[32:35], v[80:83]
    s_waitcnt lgkmcnt(2)
    v_mfma_f32_16x16x32_bf16 v[88:91], v[156:159], v[36:39], v[88:91]
    s_waitcnt lgkmcnt(1)
    v_mfma_f32_16x16x32_bf16 v[80:83], v[160:163], v[40:43], v[80:83]
    s_waitcnt lgkmcnt(0)
    v_mfma_f32_16x16x32_bf16 v[88:91], v[164:167], v[44:47], v[88:91]
    s_nop 7
    v_add_f32 v80, v80, v88
    v_add_f32 v81, v81, v89
    v_add_f32 v82, v82, v90
    v_add_f32 v83, v83, v91
    v_perm_b32 v84, v81, v80, s63
    v_perm_b32 v85, v82, v81, s68
    v_perm_b32 v86, v83, v82, s69
    buffer_store_dwordx4 v[84:87], v211, s[28:31], s51 offen sc1
    s_cmp_ge_u32 s3, 2
    s_cbranch_scc1 L_fin
    s_waitcnt vmcnt(0)
    s_add_u32 s60, s93, 0
    buffer_load_dwordx4 v[16:19], v212, s[28:31], s60 offen sc1
    s_add_u32 s60, s93, 32768
    buffer_load_dwordx4 v[20:23], v212, s[28:31], s60 offen sc1
    s_add_u32 s60, s93, 65536
    buffer_load_dwordx4 v[24:27], v212, s[28:31], s60 offen sc1
    s_add_u32 s60, s93, 98304
    buffer_load_dwordx4 v[28:31], v212, s[28:31], s60 offen sc1
    s_mov_b32 s62, 0
    s_mov_b32 s63, 0x0504030c
    s_mov_b32 s68, 0x0403020c
    s_mov_b32 s69, 0xffffff00
    v_lshlrev_b32 v9, 3, v1
L_fpoll:
    s_add_u32 s62, s62, 1
    s_waitcnt vmcnt(0)
    v_xor_b32 v10, s58, v19
    v_xor_b32 v11, s58, v23
    v_xor_b32 v12, s58, v27
    v_xor_b32 v13, s58, v31
    v_or3_b32 v10, v10, v11, v12
    v_or_b32 v10, v10, v13
    v_cmp_ne_u32 vcc, 0, v10
    s_cmp_gt_u32 s62, 0x1000000
    s_cbranch_scc1 L_fpoll_done
    s_nop 3
    s_cbranch_vccz L_fpoll_done
    s_mov_b64 exec, vcc
    s_sleep 2
    s_add_u32 s60, s93, 0
    buffer_load_dwordx4 v[16:19], v212, s[28:31], s60 offen sc1
    s_add_u32 s60, s93, 32768
    buffer_load_dwordx4 v[20:23], v212, s[28:31], s60 offen sc1
    s_add_u32 s60, s93, 65536
    buffer_load_dwordx4 v[24:27], v212, s[28:31], s60 offen sc1
    s_add_u32 s60, s93, 98304
    buffer_load_dwordx4 v[28:31], v212, s[28:31], s60 offen sc1
    s_branch L_fpoll
L_fpoll_done:
    s_mov_b64 exec, -1
    v_lshlrev_b32 v32, 8, v16
    v_perm_b32 v33, v17, v16, s63
    v_perm_b32 v34, v18, v17, s68
    v_and_b32 v35, s69, v18
    v_lshlrev_b32 v36, 8, v20
    v_perm_b32 v37, v21, v20, s63
    v_perm_b32 v38, v22, v21, s68
    v_and_b32 v39, s69, v22
    v_lshlrev_b32 v40, 8, v24
    v_perm_b32 v41, v25, v24, s63
    v_perm_b32 v42, v26, v25, s68
    v_and_b32 v43, s69, v26
    v_lshlrev_b32 v44, 8, v28
    v_perm_b32 v45, v29, v28, s63
    v_perm_b32 v46, v30, v29, s68
    v_and_b32 v47, s69, v30
    v_add_f32 v32, v32, v36
    v_add_f32 v40, v40, v44
    v_add_f32 v33, v33, v37
    v_add_f32 v41, v41, v45
    v_add_f32 v34, v34, v38
    v_add_f32 v42, v42, v46
    v_add_f32 v35, v35, v39
    v_add_f32 v43, v43, v47
    v_add_f32 v20, v32, v40
    v_add_f32 v21, v33, v41
    v_add_f32 v22, v34, v42
    v_add_f32 v23, v35, v43
    v_mov_b32 v24, v20
    v_mov_b32 v25, v21
    v_mov_b32 v26, v22
    v_mov_b32 v27, v23
    s_nop 0
    v_permlane16_swap_b32 v20, v24
    v_permlane16_swap_b32 v21, v25
    v_permlane16_swap_b32 v22, v26
    v_permlane16_swap_b32 v23, v27
    v_add_f32 v20, v20, v24
    v_add_f32 v21, v21, v25
    v_add_f32 v22, v22, v26
    v_add_f32 v23, v23, v27
    v_mov_b32 v24, v20
    v_mov_b32 v25, v21
    v_mov_b32 v26, v22
    v_mov_b32 v27, v23
    s_nop 0
    v_permlane32_swap_b32 v20, v24
    v_permlane32_swap_b32 v21, v25
    v_permlane32_swap_b32 v22, v26
    v_permlane32_swap_b32 v23, v27
    v_add_f32 v20, v20, v24
    v_add_f32 v21, v21, v25
    v_add_f32 v22, v22, v26
    v_add_f32 v23, v23, v27
    v_cvt_pk_bf16_f32 v28, v20, v21
    v_cvt_pk_bf16_f32 v29, v22, v23
    s_mov_b64 exec, 0xffff
    buffer_store_dwordx2 v[28:29], v9, s[32:35], s94 offen
    s_mov_b64 exec, -1
    s_or_b32 s60, s4, s53
    s_or_b32 s60, s60, s3
    s_cmp_lg_u32 s60, 0
    s_cbranch_scc1 L_fin
    s_load_dword s63, s[64:65], 0
    s_lshl_b32 s60, s52, 8
    s_add_u32 s60, s60, 262144
    s_waitcnt lgkmcnt(0)
    s_add_u32 s63, s63, 1
    v_mov_b32 v9, s63
    v_mov_b32 v10, 0
    s_mov_b64 exec, 1
    buffer_store_dword v9, v10, s[28:31], s60 offen sc1
    s_mov_b64 exec, -1
L_fin:
L_end:
    s_endpgm
.section .rodata,"a"
.p2align 6
.amdhsa_kernel standalone__sliding_block_cached__sampling_kernel
  .amdhsa_next_free_vgpr 220
  .amdhsa_next_free_sgpr 102
  .amdhsa_accum_offset 220
  .amdhsa_group_segment_fixed_size 0
  .amdhsa_kernarg_size 64
  .amdhsa_user_sgpr_count 2
  .amdhsa_user_sgpr_kernarg_segment_ptr 1
  .amdhsa_system_sgpr_workgroup_id_x 1
  .amdhsa_float_denorm_mode_32 3
  .amdhsa_float_denorm_mode_16_64 3
.end_amdhsa_kernel
```
